```python
import torch

def _softmax(x, axis=-1):
    return torch.softmax(x, dim=axis)
def _gelu(x):
    return torch.nn.functional.gelu(x, approximate="tanh")
def _silu(x):
    return torch.nn.functional.silu(x)
def _sigmoid(x):
    return torch.sigmoid(x)
def _layernorm(x, axis=-1, eps=1e-5):
    m = x.mean(dim=axis, keepdim=True)
    v = x.var(dim=axis, keepdim=True, unbiased=False)
    return (x - m) / torch.sqrt(v + eps)
def _scatter_add(tgt, idx, src, axis=0):
    return tgt.clone().index_add_(axis, idx, src)
def _segment_sum(src, seg, n):
    out = torch.zeros((n,) + src.shape[1:], dtype=src.dtype)
    return out.index_add_(0, seg, src)
def _pad(x, pw):
    flat = tuple(v for pair in reversed(pw) for v in pair)
    return torch.nn.functional.pad(x, flat)

kernel_name = 'concat_heads__softmax_full_mha__softmax_full_mha__prompt'

def setup_inputs():

    _w = (lambda a: (lambda t: t.to(torch.bfloat16) if t.is_floating_point() else t)(torch.as_tensor(a)))
    def _A_setup():
        B, S, D = 1, 2048, 448
        return {
            "x": _w((lambda *s: torch.randn(*s, dtype=torch.bfloat16) * 0.2)(B, S, D)),
            "wqkv": _w((lambda *s: torch.randn(*s, dtype=torch.bfloat16) * 0.2)(D, 3 * D)),
            "wo": _w((lambda *s: torch.randn(*s, dtype=torch.bfloat16) * 0.05)(D, D)),
        }
    _A_in = _A_setup()

    def _B_setup():
        B, S, D = 1, 2048, 448
        return {
            "x": _w((lambda *s: torch.randn(*s, dtype=torch.bfloat16) * 0.2)(B, S, D)),
            "wqkv": _w((lambda *s: torch.randn(*s, dtype=torch.bfloat16) * 0.2)(D, 3 * D)),
            "wo": _w((lambda *s: torch.randn(*s, dtype=torch.bfloat16) * 0.05)(D, D)),
        }
    _B_in = _B_setup()

    return {
        "A_x": _A_in["x"],
        "A_wqkv": _A_in["wqkv"],
        "A_wo": _A_in["wo"],
        "B_x": _B_in["x"],
        "B_wqkv": _B_in["wqkv"],
        "B_wo": _B_in["wo"],
    }

def reference(A_x, A_wqkv, A_wo, B_x, B_wqkv, B_wo):
    def _A_ref(x, wqkv, wo):
        B, S, D = x.shape
        H = 16; Dh = D // H
        qkv = (lambda x, *d: x.permute(*d))((x @ wqkv).reshape(B, S, 3, H, Dh), 2, 0, 3, 1, 4)
        q, k, v = qkv[0], qkv[1], qkv[2]
        scale = Dh ** -0.5
        scores = torch.einsum("bhqd,bhkd->bhqk", q, k) * scale
        p = _softmax(scores, axis=-1)
        o = torch.einsum("bhqk,bhkd->bhqd", p, v)
        return (lambda x, *d: x.permute(*d))(o, 0, 2, 1, 3).reshape(B, S, D) @ wo

    def _B_ref(x, wqkv, wo):
        B, S, D = x.shape
        H = 16; Dh = D // H
        qkv = (lambda x, *d: x.permute(*d))((x @ wqkv).reshape(B, S, 3, H, Dh), 2, 0, 3, 1, 4)
        q, k, v = qkv[0], qkv[1], qkv[2]
        scale = Dh ** -0.5
        scores = torch.einsum("bhqd,bhkd->bhqk", q, k) * scale
        p = _softmax(scores, axis=-1)
        o = torch.einsum("bhqk,bhkd->bhqd", p, v)
        return (lambda x, *d: x.permute(*d))(o, 0, 2, 1, 3).reshape(B, S, D) @ wo

    a = _A_ref(A_x, A_wqkv, A_wo)
    b = _B_ref(B_x, B_wqkv, B_wo)
    return torch.concatenate([a, b], axis=-1)
```

```asm
; @launch grid=(256,1,1) block=(512,1,1) lds=163840
.amdgcn_target "amdgcn-amd-amdhsa--gfx950"
.text
.globl concat_heads__softmax_full_mha__softmax_full_mha__prompt_kernel
.p2align 12
.p2align 8
.type concat_heads__softmax_full_mha__softmax_full_mha__prompt_kernel,@function
concat_heads__softmax_full_mha__softmax_full_mha__prompt_kernel:
    s_cmp_ge_u32 s2, 256
    s_cbranch_scc1 L_end
    s_load_dwordx16 s[4:19], s[0:1], 0
    s_load_dwordx2 s[20:21], s[0:1], 64
    s_memrealtime s[78:79]
    s_and_b32 s40, s2, 7
    s_lshr_b32 s41, s2, 3
    v_lshrrev_b32 v1, 6, v0
    v_and_b32 v0, 63, v0
    v_readfirstlane_b32 s46, v1
    s_lshl_b32 s58, s40, 2
    s_lshr_b32 s58, 0x76453210, s58
    s_bfe_u32 s42, s58, 0x10002
    s_and_b32 s49, s58, 3
    s_lshr_b32 s43, s41, 1
    s_and_b32 s44, s41, 1
    s_cmp_ge_u32 s46, 4
    s_cbranch_scc1 L_comp
    v_lshrrev_b32 v240, 3, v0
    v_lshrrev_b32 v241, 4, v0
    v_and_b32 v242, 7, v0
    s_lshl_b32 s58, s43, 7
    s_lshl_b32 s59, s46, 5
    s_add_u32 s58, s58, s59
    v_add_u32 v243, s58, v240
    v_mul_u32_u24 v243, 896, v243
    v_xor_b32 v244, v242, v241
    v_lshl_add_u32 v16, v244, 4, v243
    v_xor_b32 v17, 64, v16
    v_add_u32 v17, 6144, v17
    s_mul_i32 s58, s49, 224
    s_mul_i32 s59, s46, 43008
    s_add_u32 s58, s58, s59
    s_mul_i32 s59, s44, 896
    s_add_u32 s59, s59, s58
    s_add_u32 s59, s59, 896
    v_lshlrev_b32 v243, 2, v241
    v_and_b32 v244, 15, v0
    v_xor_b32 v244, v244, v243
    v_cmp_lt_u32 vcc, 13, v244
    v_mul_u32_u24 v241, 2688, v241
    v_lshl_add_u32 v241, v244, 4, v241
    v_add_u32 v18, s59, v241
    v_bfrev_b32 v244, 2
    v_cndmask_b32 v18, v18, v244, vcc
    s_mul_i32 s59, s44, 112
    s_add_u32 s59, s59, s58
    v_and_b32 v243, 4, v243
    v_xor_b32 v242, v242, v243
    v_cmp_lt_u32 vcc, 6, v242
    v_mul_u32_u24 v240, 2688, v240
    v_lshl_add_u32 v240, v242, 4, v240
    v_add_u32 v19, s59, v240
    v_cndmask_b32 v19, v19, v244, vcc
    s_mul_i32 s62, s43, 1
    s_mul_i32 s61, s49, 2
    s_add_u32 s62, s62, s61
    s_mul_i32 s61, s62, 9363
    s_lshr_b32 s61, s61, 16
    s_mul_i32 s61, s61, 7
    s_sub_u32 s62, s62, s61
    s_lshl_b32 s52, s46, 12
    s_add_u32 s52, s52, 24576
    s_mul_i32 s51, s46, 6144
    s_mov_b32 s26, 1835008
    s_mov_b32 s27, 0x00020000
    s_mov_b32 s30, 1204224
    s_mov_b32 s31, 0x00020000
    s_lshl_b32 s45, s62, 7
    s_mul_i32 s53, s62, 172032
    s_add_u32 m0, s52, 0
    s_add_u32 s62, s62, 1
    s_cmp_eq_u32 s62, 7
    s_cselect_b32 s62, 0, s62
    v_add_u32 v20, 12288, v16
    v_add_u32 v21, 12288, v17
    v_add_u32 v22, 10752, v18
    v_add_u32 v23, 19456, v18
    v_add_u32 v24, 29184, v18
    v_add_u32 v25, 18432, v19
    s_cmp_eq_u32 s42, 0
    s_waitcnt lgkmcnt(0)
    s_cselect_b32 s24, s4, s10
    s_cselect_b32 s25, s5, s11
    s_cselect_b32 s28, s6, s12
    s_cselect_b32 s29, s7, s13
    buffer_load_dwordx4 v16, s[24:27], s45 offen offset:0 lds
    buffer_load_dwordx4 v17, s[24:27], s45 offen offset:1024 lds
    buffer_load_dwordx4 v20, s[24:27], s45 offen offset:2048 lds
    buffer_load_dwordx4 v21, s[24:27], s45 offen offset:3072 lds
    s_add_u32 m0, s51, 0
    s_nop 0
    buffer_load_dwordx4 v18, s[28:31], s53 offen lds
    s_add_u32 m0, s51, 1024
    s_nop 0
    buffer_load_dwordx4 v22, s[28:31], s53 offen offset:0 lds
    buffer_load_dwordx4 v23, s[28:31], s53 offen offset:2048 lds
    buffer_load_dwordx4 v24, s[28:31], s53 offen offset:3072 lds
    s_add_u32 m0, s51, 2048
    s_nop 0
    buffer_load_dwordx4 v19, s[28:31], s53 offen offset:0 lds
    buffer_load_dwordx4 v25, s[28:31], s53 offen offset:3072 lds
    s_mov_b32 s68, s18
    s_mov_b32 s69, s19
    s_mov_b32 s70, 256
    s_mov_b32 s71, 0x00020000
    s_lshl_b32 s60, s42, 3
    s_cmp_eq_u32 s42, 0
    s_cselect_b32 s36, s8, s14
    s_cselect_b32 s37, s9, s15
    s_mov_b32 s38, 401408
    s_mov_b32 s39, 0x00020000
    s_mov_b32 s64, s16
    s_mov_b32 s65, s17
    s_mov_b32 s66, 3670016
    s_mov_b32 s67, 0x00020000
    s_lshl_b32 s61, s40, 21
    s_add_u32 s32, s20, s61
    s_addc_u32 s33, s21, 0
    s_mov_b32 s34, 2097152
    s_mov_b32 s35, 0x00020000
    s_lshl_b32 s61, s42, 21
    s_add_u32 s61, s61, 16777216
    s_add_u32 s12, s20, s61
    s_addc_u32 s13, s21, 0
    s_mov_b32 s14, 2097152
    s_mov_b32 s15, 0x00020000
    s_mov_b32 s50, 0
    s_and_b32 s48, s43, 1
    s_lshl_b32 s47, s44, 1
    s_add_u32 s47, s47, s48
    s_lshl_b32 s61, s47, 18
    s_add_u32 s72, s32, s61
    s_addc_u32 s73, s33, 0
    s_mov_b32 s74, 262144
    s_mov_b32 s75, 0x00020000
    s_and_b32 s56, s46, 3
    s_lshl_b32 s16, s56, 16
    v_and_b32 v240, 15, v0
    v_lshlrev_b32 v240, 3, v240
    s_lshl_b32 s58, s44, 2
    s_add_u32 s58, s58, s56
    s_mul_i32 s58, s58, 128
    s_add_u32 s58, s58, 1048576
    v_add_u32 v4, s58, v240
    s_lshr_b32 s58, s43, 1
    s_lshl_b32 s58, s58, 7
    s_add_u32 s17, s58, s16
    v_lshlrev_b32 v235, 10, v0
    v_lshlrev_b32 v1, 4, v0
    v_lshlrev_b32 v6, 3, v0
    v_lshlrev_b32 v240, 2, v0
    v_mov_b32 v2, 0xdddddddd
    s_lshl_b32 s59, s56, 8
    s_add_u32 s59, s59, 106496
    v_add_u32 v7, s59, v240
    s_mul_i32 s59, s56, 12288
    s_add_u32 s59, s59, 57344
    v_add_u32 v14, s59, v1
    s_add_u32 s58, s56, 1
    s_and_b32 s58, s58, 3
    s_lshl_b32 s59, s58, 8
    s_add_u32 s59, s59, 106496
    v_add_u32 v8, s59, v240
    s_mul_i32 s59, s58, 12288
    s_add_u32 s59, s59, 57344
    v_add_u32 v11, s59, v1
    s_add_u32 s58, s56, 2
    s_and_b32 s58, s58, 3
    s_lshl_b32 s59, s58, 8
    s_add_u32 s59, s59, 106496
    v_add_u32 v9, s59, v240
    s_mul_i32 s59, s58, 12288
    s_add_u32 s59, s59, 61440
    v_add_u32 v12, s59, v1
    s_add_u32 s58, s56, 3
    s_and_b32 s58, s58, 3
    s_lshl_b32 s59, s58, 8
    s_add_u32 s59, s59, 106496
    v_add_u32 v10, s59, v240
    s_mul_i32 s59, s58, 12288
    s_add_u32 s59, s59, 65536
    v_add_u32 v13, s59, v1
    v_mov_b32 v3, 163808
    v_mov_b32 v5, 1
    s_lshl_b32 s9, s43, 2
    s_add_u32 s9, s9, s56
    s_lshl_b32 s58, s49, 2
    s_lshr_b32 s58, 0x2640, s58
    s_and_b32 s58, s58, 7
    s_add_u32 s58, s58, s44
    s_lshl_b32 s59, s48, 3
    s_add_u32 s58, s58, s59
    s_lshl_b32 s59, s9, 4
    s_add_u32 s59, s59, s58
    s_mul_i32 s19, s59, 1792
    s_mul_i32 s22, s59, 32
    s_add_u32 s22, s22, 1835008
    v_lshrrev_b32 v242, 5, v0
    s_and_b32 s59, s41, 3
    s_cmp_eq_u32 s59, 3
    s_cselect_b32 s58, 8, 16
    s_lshl_b32 s59, s59, 8
    v_lshrrev_b32 v240, 4, v0
    v_lshlrev_b32 v241, 2, v240
    v_and_b32 v243, 15, v0
    v_xor_b32 v241, v241, v243
    v_cmp_le_u32 vcc, s58, v241
    v_mul_u32_u24 v240, 896, v240
    v_lshl_add_u32 v240, v241, 4, v240
    v_add_u32 v172, s59, v240
    v_bfrev_b32 v240, 2
    v_cndmask_b32 v172, v172, v240, vcc
    s_lshl_b32 s61, s56, 2
    s_cmp_lt_u32 s61, s58
    s_cselect_b32 s4, 1, 0
    s_mul_i32 s8, s42, 896
    s_add_u32 s8, s8, s59
    s_and_b32 s61, s56, 2
    s_lshl_b32 s59, s61, 6
    s_add_u32 s8, s8, s59
    s_lshl_b32 s7, s49, 3
    s_lshr_b32 s58, s41, 2
    s_add_u32 s7, s7, s58
    s_bfe_u32 s11, s7, 0x10001
    s_lshl_b32 s7, s7, 1
    v_bfe_u32 v240, v0, 2, 2
    v_xor_b32 v241, s61, v240
    v_lshlrev_b32 v241, 6, v241
    v_lshl_add_u32 v241, v240, 8, v241
    v_and_b32 v240, 1, v0
    v_lshl_add_u32 v241, v240, 5, v241
    v_bfe_u32 v240, v0, 4, 1
    v_lshl_add_u32 v241, v240, 4, v241
    v_bfe_u32 v240, v0, 1, 1
    v_lshl_add_u32 v241, v240, 3, v241
    v_mul_u32_u24 v240, 1024, v242
    v_add_u32 v160, v241, v240
    v_mul_u32_u24 v240, 7168, v242
    v_add_u32 v161, v241, v240
    v_mul_u32_u24 v240, 14336, v242
    v_add_u32 v162, v241, v240
    s_and_b32 s61, s56, 1
    s_mul_i32 s59, s61, 14336
    s_add_u32 s59, s59, 57344
    v_add_u32 v168, s59, v1
    v_and_b32 v240, 31, v0
    v_mul_u32_u24 v241, 1792, v242
    v_lshl_add_u32 v241, v240, 4, v241
    v_add_u32 v169, s59, v241
    v_mul_u32_u24 v241, 3584, v242
    v_lshl_add_u32 v241, v240, 3, v241
    v_add_u32 v170, s59, v241
    s_lshl_b32 s58, s56, 12
    s_add_u32 s58, s58, 122880
    v_add_u32 v175, s58, v1
    v_and_b32 v241, 7, v0
    v_lshlrev_b32 v243, 1, v242
    v_xor_b32 v241, v241, v243
    v_lshlrev_b32 v241, 4, v241
    v_lshl_add_u32 v241, v240, 7, v241
    v_add_u32 v166, s58, v241
    v_lshrrev_b32 v240, 3, v0
    v_xor_b32 v241, v240, v0
    v_and_b32 v241, 7, v241
    s_add_u32 s58, s7, s61
    s_lshl_b32 s58, s58, 5
    v_add_u32 v240, s58, v240
    v_mul_u32_u24 v240, 1792, v240
    v_lshl_add_u32 v174, v241, 4, v240
    s_lshl_b32 s58, s61, 2
    s_add_u32 s58, s58, 163824
    v_mov_b32 v167, s58
    s_lshr_b32 s59, s56, 1
    s_add_u32 s58, s7, s59
    s_lshl_b32 s58, s58, 4
    s_lshl_b32 s59, s11, 3
    s_add_u32 s58, s58, s59
    s_and_b32 s59, s56, 1
    s_lshl_b32 s59, s59, 1
    s_lshl_b32 s59, s59, 1
    s_add_u32 s7, s58, s59
    v_and_b32 v240, 3, v0
    v_add_u32 v240, s7, v240
    v_mul_u32_u24 v240, 32, v240
    v_add_u32 v173, 1835008, v240
    s_lshl_b32 s59, s48, 13
    s_add_u32 s59, s59, 122880
    s_add_u32 s58, s56, 1
    s_and_b32 s58, s58, 3
    s_lshl_b32 s58, s58, 11
    s_add_u32 s58, s58, s59
    v_add_u32 v240, s58, v1
    s_add_u32 s58, s56, 2
    s_and_b32 s58, s58, 3
    s_lshl_b32 s58, s58, 11
    s_add_u32 s58, s58, s59
    v_add_u32 v241, s58, v1
    s_add_u32 s58, s56, 3
    s_and_b32 s58, s58, 3
    s_lshl_b32 s58, s58, 11
    s_add_u32 s58, s58, s59
    v_add_u32 v242, s58, v1
    s_add_u32 s58, s56, 4
    s_and_b32 s58, s58, 3
    s_lshl_b32 s58, s58, 11
    s_add_u32 s58, s58, s59
    v_add_u32 v243, s58, v1
    v_mov_b32 v244, 163816
    s_lshl_b32 s45, s62, 7
    s_mul_i32 s53, s62, 172032
    s_add_u32 m0, s52, 40960
    s_add_u32 s62, s62, 1
    s_cmp_eq_u32 s62, 7
    s_cselect_b32 s62, 0, s62
    buffer_load_dwordx4 v16, s[24:27], s45 offen offset:0 lds
    buffer_load_dwordx4 v17, s[24:27], s45 offen offset:1024 lds
    buffer_load_dwordx4 v20, s[24:27], s45 offen offset:2048 lds
    buffer_load_dwordx4 v21, s[24:27], s45 offen offset:3072 lds
    s_add_u32 m0, s51, 40960
    s_nop 0
    buffer_load_dwordx4 v18, s[28:31], s53 offen lds
    s_add_u32 m0, s51, 41984
    s_nop 0
    buffer_load_dwordx4 v22, s[28:31], s53 offen offset:0 lds
    buffer_load_dwordx4 v23, s[28:31], s53 offen offset:2048 lds
    buffer_load_dwordx4 v24, s[28:31], s53 offen offset:3072 lds
    s_add_u32 m0, s51, 43008
    s_nop 0
    buffer_load_dwordx4 v19, s[28:31], s53 offen offset:0 lds
    buffer_load_dwordx4 v25, s[28:31], s53 offen offset:3072 lds
    s_lshl_b32 s45, s62, 7
    s_mul_i32 s53, s62, 172032
    s_add_u32 m0, s52, 81920
    s_add_u32 s62, s62, 1
    s_cmp_eq_u32 s62, 7
    s_cselect_b32 s62, 0, s62
    s_waitcnt vmcnt(10)
    s_barrier
    buffer_load_dwordx4 v16, s[24:27], s45 offen offset:0 lds
    buffer_load_dwordx4 v17, s[24:27], s45 offen offset:1024 lds
    buffer_load_dwordx4 v20, s[24:27], s45 offen offset:2048 lds
    buffer_load_dwordx4 v21, s[24:27], s45 offen offset:3072 lds
    s_add_u32 m0, s51, 81920
    s_nop 0
    buffer_load_dwordx4 v18, s[28:31], s53 offen lds
    s_add_u32 m0, s51, 82944
    s_nop 0
    buffer_load_dwordx4 v22, s[28:31], s53 offen offset:0 lds
    buffer_load_dwordx4 v23, s[28:31], s53 offen offset:2048 lds
    buffer_load_dwordx4 v24, s[28:31], s53 offen offset:3072 lds
    s_add_u32 m0, s51, 83968
    s_nop 0
    buffer_load_dwordx4 v19, s[28:31], s53 offen offset:0 lds
    buffer_load_dwordx4 v25, s[28:31], s53 offen offset:3072 lds
    s_lshl_b32 s45, s62, 7
    s_mul_i32 s53, s62, 172032
    s_add_u32 m0, s52, 0
    s_add_u32 s62, s62, 1
    s_cmp_eq_u32 s62, 7
    s_cselect_b32 s62, 0, s62
    s_waitcnt vmcnt(10)
    s_barrier
    buffer_load_dwordx4 v16, s[24:27], s45 offen offset:0 lds
    buffer_load_dwordx4 v17, s[24:27], s45 offen offset:1024 lds
    buffer_load_dwordx4 v20, s[24:27], s45 offen offset:2048 lds
    buffer_load_dwordx4 v21, s[24:27], s45 offen offset:3072 lds
    s_add_u32 m0, s51, 0
    s_nop 0
    buffer_load_dwordx4 v18, s[28:31], s53 offen lds
    s_add_u32 m0, s51, 1024
    s_nop 0
    buffer_load_dwordx4 v22, s[28:31], s53 offen offset:0 lds
    buffer_load_dwordx4 v23, s[28:31], s53 offen offset:2048 lds
    buffer_load_dwordx4 v24, s[28:31], s53 offen offset:3072 lds
    s_add_u32 m0, s51, 2048
    s_nop 0
    buffer_load_dwordx4 v19, s[28:31], s53 offen offset:0 lds
    buffer_load_dwordx4 v25, s[28:31], s53 offen offset:3072 lds
    s_lshl_b32 s45, s62, 7
    s_mul_i32 s55, s62, 172032
    s_add_u32 m0, s52, 40960
    s_add_u32 s62, s62, 1
    s_cmp_eq_u32 s62, 7
    s_cselect_b32 s62, 0, s62
    s_waitcnt vmcnt(10)
    s_barrier
    buffer_load_dwordx4 v16, s[24:27], s45 offen offset:0 lds
    buffer_load_dwordx4 v17, s[24:27], s45 offen offset:1024 lds
    buffer_load_dwordx4 v20, s[24:27], s45 offen offset:2048 lds
    buffer_load_dwordx4 v21, s[24:27], s45 offen offset:3072 lds
    s_add_u32 m0, s51, 40960
    s_nop 0
    buffer_load_dwordx4 v18, s[28:31], s55 offen lds
    s_add_u32 m0, s51, 41984
    s_nop 0
    buffer_load_dwordx4 v22, s[28:31], s55 offen offset:0 lds
    buffer_load_dwordx4 v23, s[28:31], s55 offen offset:2048 lds
    buffer_load_dwordx4 v24, s[28:31], s55 offen offset:3072 lds
    s_lshl_b32 s45, s62, 7
    s_mul_i32 s57, s62, 172032
    s_add_u32 m0, s52, 81920
    s_add_u32 s62, s62, 1
    s_cmp_eq_u32 s62, 7
    s_cselect_b32 s62, 0, s62
    s_waitcnt vmcnt(8)
    s_barrier
    buffer_load_dwordx4 v16, s[24:27], s45 offen offset:0 lds
    buffer_load_dwordx4 v17, s[24:27], s45 offen offset:1024 lds
    buffer_load_dwordx4 v20, s[24:27], s45 offen offset:2048 lds
    buffer_load_dwordx4 v21, s[24:27], s45 offen offset:3072 lds
    s_add_u32 m0, s51, 81920
    s_nop 0
    buffer_load_dwordx4 v18, s[28:31], s57 offen lds
    s_add_u32 m0, s51, 82944
    s_nop 0
    buffer_load_dwordx4 v22, s[28:31], s57 offen offset:0 lds
    buffer_load_dwordx4 v23, s[28:31], s57 offen offset:2048 lds
    buffer_load_dwordx4 v24, s[28:31], s57 offen offset:3072 lds
    s_lshl_b32 s58, s49, 5
    s_add_u32 s58, s58, 128
    s_load_dwordx2 s[76:77], s[68:69], s60
    s_load_dwordx8 s[88:95], s[68:69], s58
    s_lshl_b32 s45, s62, 7
    s_mul_i32 s23, s62, 172032
    s_add_u32 m0, s52, 0
    s_add_u32 s62, s62, 1
    s_cmp_eq_u32 s62, 7
    s_cselect_b32 s62, 0, s62
    s_waitcnt vmcnt(8)
    s_barrier
    buffer_load_dwordx4 v16, s[24:27], s45 offen offset:0 lds
    buffer_load_dwordx4 v17, s[24:27], s45 offen offset:1024 lds
    buffer_load_dwordx4 v20, s[24:27], s45 offen offset:2048 lds
    buffer_load_dwordx4 v21, s[24:27], s45 offen offset:3072 lds
    s_add_u32 m0, s51, 0
    s_nop 0
    buffer_load_dwordx4 v18, s[28:31], s23 offen lds
    s_add_u32 m0, s51, 1024
    s_nop 0
    buffer_load_dwordx4 v22, s[28:31], s23 offen offset:0 lds
    buffer_load_dwordx4 v23, s[28:31], s23 offen offset:2048 lds
    buffer_load_dwordx4 v24, s[28:31], s23 offen offset:3072 lds
    s_waitcnt vmcnt(8)
    s_barrier
    s_add_u32 m0, s51, 2048
    s_nop 0
    buffer_load_dwordx4 v19, s[28:31], s23 offen offset:0 lds
    buffer_load_dwordx4 v25, s[28:31], s23 offen offset:3072 lds
    s_add_u32 m0, s51, 43008
    s_nop 0
    buffer_load_dwordx4 v19, s[28:31], s55 offen offset:0 lds
    buffer_load_dwordx4 v25, s[28:31], s55 offen offset:3072 lds
    s_add_u32 m0, s51, 83968
    s_nop 0
    buffer_load_dwordx4 v19, s[28:31], s57 offen offset:0 lds
    buffer_load_dwordx4 v25, s[28:31], s57 offen offset:3072 lds
    buffer_load_dword v249, v4, s[32:35], 0 offen sc1
    s_mov_b32 exec_lo, 0xfff
    s_mov_b32 exec_hi, 0x0
    buffer_load_dword v248, v235, s[72:75], s17 offen sc1
    s_mov_b64 exec, -1
    s_getreg_b32 s61, hwreg(HW_REG_XCC_ID)
    s_and_b32 s61, s61, 15
    s_lshl_b32 s58, s40, 4
    s_or_b32 s61, s61, s58
    s_or_b32 s61, s61, 0x80
    s_mul_i32 s61, s61, 0x01010101
    s_lshl_b32 s58, s46, 4
    s_add_u32 s58, s58, 139264
    v_mov_b32 v246, s58
    s_waitcnt lgkmcnt(0)
    s_xor_b32 s59, s88, s61
    s_xor_b32 s58, s89, s61
    s_or_b32 s59, s59, s58
    s_xor_b32 s58, s90, s61
    s_or_b32 s59, s59, s58
    s_xor_b32 s58, s91, s61
    s_or_b32 s59, s59, s58
    s_xor_b32 s58, s92, s61
    s_or_b32 s59, s59, s58
    s_xor_b32 s58, s93, s61
    s_or_b32 s59, s59, s58
    s_xor_b32 s58, s94, s61
    s_or_b32 s59, s59, s58
    s_xor_b32 s58, s95, s61
    s_or_b32 s59, s59, s58
    v_mov_b32 v232, s76
    v_mov_b32 v233, s77
    v_mov_b32 v234, s59
    ds_write_b96 v246, v[232:234]
    s_waitcnt lgkmcnt(0)
    s_waitcnt vmcnt(8)
    s_barrier
    s_lshl_b32 s58, s49, 3
    s_lshr_b32 s59, s41, 2
    s_add_u32 s58, s58, s59
    s_and_b32 s59, s58, 2
    s_xor_b32 s59, s59, 2
    s_lshl_b32 s59, s59, 2
    s_lshl_b32 s58, s58, 5
    s_add_u32 s58, s58, s59
    s_and_b32 s59, s56, 1
    s_mul_i32 s51, s59, 14336
    s_lshl_b32 s59, s59, 4
    s_add_u32 s58, s58, s59
    s_and_b32 s59, s56, 2
    s_lshl_b32 s59, s59, 1
    s_add_u32 s58, s58, s59
    v_and_b32 v163, 3, v0
    v_add_u32 v163, s58, v163
    v_mul_u32_u24 v163, 32, v163
    v_add_u32 v163, 1835008, v163
    s_mul_i32 s43, s58, 1792
    s_add_u32 s57, s43, 4096
    s_mul_i32 s59, s59, 1792
    s_add_u32 s51, s51, s59
    s_add_u32 s51, s51, 86016
    s_lshl_b32 s59, s56, 2
    s_add_u32 s59, s59, 163824
    v_mov_b32 v164, s59
    v_mov_b32 v165, 163808
    v_mov_b32 v112, 0
    v_mov_b32 v113, 0
    v_mov_b32 v114, 0
    v_mov_b32 v115, 0
    s_nop 1
    v_mfma_f32_32x32x16_bf16 v[48:63], v[112:115], v[112:115], 0
    v_mfma_f32_32x32x16_bf16 v[64:79], v[112:115], v[112:115], 0
    v_mfma_f32_32x32x16_bf16 v[80:95], v[112:115], v[112:115], 0
    v_mfma_f32_32x32x16_bf16 v[96:111], v[112:115], v[112:115], 0
    s_add_u32 s58, s72, s16
    s_addc_u32 s59, s73, 0
    s_add_u32 s24, s58, 4096
    s_addc_u32 s25, s59, 0
    s_add_u32 s26, s58, 12288
    s_addc_u32 s27, s59, 0
    s_add_u32 s28, s58, 20480
    s_addc_u32 s29, s59, 0
    s_add_u32 s30, s58, 28672
    s_addc_u32 s31, s59, 0
    s_add_u32 s44, s58, 36864
    s_addc_u32 s45, s59, 0
    s_add_u32 s52, s58, 45056
    s_addc_u32 s53, s59, 0
    s_add_u32 s54, s58, 53248
    s_addc_u32 s55, s59, 0
    s_add_u32 s20, s58, 61440
    s_addc_u32 s21, s59, 0
    s_lshl_b32 s58, s41, 2
    s_add_u32 s58, s58, s56
    s_mul_i32 s58, s58, 25
    v_min_u32 v15, 24, v0
    v_add_u32 v15, s58, v15
    v_lshlrev_b32 v15, 7, v15
    s_waitcnt vmcnt(2)
    s_barrier
    s_mov_b32 s63, 4194304
L_nonceL:
    v_readfirstlane_b32 s76, v232
    v_readfirstlane_b32 s77, v233
    s_cmp_lg_u32 s76, 0
    s_cselect_b32 s61, s77, 0
    s_cmp_lg_u32 s61, 0
    s_cbranch_scc0 L_nonce_retryL
    s_setprio 2
    s_branch L_ph2
L_comp:
    s_setprio 3
    s_getreg_b32 s61, hwreg(HW_REG_XCC_ID)
    s_and_b32 s61, s61, 15
    s_lshl_b32 s58, s40, 4
    s_or_b32 s61, s61, s58
    s_or_b32 s61, s61, 0x80
    s_lshl_b32 s59, s49, 5
    s_add_u32 s59, s59, 128
    v_mov_b32 v232, s61
    s_add_u32 s59, s59, s41
    v_mov_b32 v238, 0
    v_mov_b32 v239, 0
    s_waitcnt lgkmcnt(0)
    s_mov_b32 s68, s18
    s_mov_b32 s69, s19
    s_mov_b32 s70, 256
    s_mov_b32 s71, 0x00020000
    s_lshl_b32 s60, s42, 3
    s_mov_b64 exec, 1
    s_cmp_lg_u32 s46, 4
    s_cbranch_scc1 L_noreg
    buffer_store_byte v232, off, s[68:71], s59
    s_cmp_lg_u32 s41, 0
    s_cbranch_scc1 L_noreg
    s_or_b32 s58, s78, 1
    s_or_b32 s61, s79, 1
    v_mov_b32 v236, s58
    v_mov_b32 v237, s61
    buffer_atomic_cmpswap_x2 v[236:239], off, s[68:71], s60 sc1
L_noreg:
    s_mov_b64 exec, -1
    s_and_b32 s54, s46, 1
    s_bfe_u32 s55, s46, 0x10001
    v_and_b32 v240, 31, v0
    v_bfe_u32 v241, v0, 1, 3
    v_lshrrev_b32 v242, 5, v0
    v_xor_b32 v241, v241, v242
    v_lshlrev_b32 v241, 4, v241
    v_lshl_add_u32 v241, v240, 7, v241
    s_lshl_b32 s58, s54, 13
    s_add_u32 s58, s58, 24576
    v_xor_b32 v16, 0, v241
    v_add_u32 v16, s58, v16
    v_xor_b32 v17, 32, v241
    v_add_u32 v17, s58, v17
    v_xor_b32 v18, 64, v241
    v_add_u32 v18, s58, v18
    v_xor_b32 v19, 96, v241
    v_add_u32 v19, s58, v19
    v_bfe_u32 v240, v0, 4, 1
    v_and_b32 v241, 3, v0
    v_lshlrev_b32 v241, 3, v241
    v_lshl_add_u32 v240, v240, 5, v241
    s_mul_i32 s58, s55, 112
    v_add_u32 v20, s58, v240
    v_add_u32 v21, 56, v20
    s_mul_i32 s58, s55, 56
    v_add_u32 v22, s58, v240
    s_mov_b32 exec_lo, 0x88880000
    s_mov_b32 exec_hi, 0x88880000
    v_or_b32 v20, 192, v20
    v_or_b32 v21, 192, v21
    v_or_b32 v22, 64, v22
    s_mov_b64 exec, -1
    v_bfe_u32 v241, v0, 2, 2
    v_mul_u32_u24 v242, 3072, v242
    v_lshl_add_u32 v243, v241, 8, v242
    v_lshlrev_b32 v244, 6, v241
    v_xor_b32 v20, v20, v244
    v_add_u32 v20, v20, v243
    v_xor_b32 v21, v21, v244
    v_add_u32 v21, v21, v243
    v_lshl_add_u32 v243, v241, 7, v242
    v_lshlrev_b32 v244, 5, v241
    v_and_b32 v244, 64, v244
    v_xor_b32 v22, v22, v244
    v_add_u32 v22, v22, v243
    v_mov_b32 v188, 0
    v_mov_b32 v189, 0
    v_mov_b32 v190, 0
    v_mov_b32 v191, 0
    v_mov_b32 v192, 0
    v_mov_b32 v193, 0
    v_mov_b32 v194, 0
    v_mov_b32 v195, 0
    v_mov_b32 v196, 0
    v_mov_b32 v197, 0
    v_mov_b32 v198, 0
    v_mov_b32 v199, 0
    v_mov_b32 v200, 0
    v_mov_b32 v201, 0
    v_mov_b32 v202, 0
    v_mov_b32 v203, 0
    v_mov_b32 v204, 0
    v_mov_b32 v205, 0
    v_mov_b32 v206, 0
    v_mov_b32 v207, 0
    v_mov_b32 v240, 163808
    ds_write_b128 v240, v[204:207]
    ds_write_b128 v240, v[204:207] offset:16
    v_mfma_f32_32x32x16_bf16 v[32:47], v[204:207], v[204:207], 0
    v_mfma_f32_32x32x16_bf16 v[48:63], v[204:207], v[204:207], 0
    v_mfma_f32_32x32x16_bf16 v[64:79], v[204:207], v[204:207], 0
    v_mfma_f32_32x32x16_bf16 v[80:95], v[204:207], v[204:207], 0
    v_mfma_f32_32x32x16_bf16 v[96:111], v[204:207], v[204:207], 0
    v_mfma_f32_32x32x16_bf16 v[112:127], v[204:207], v[204:207], 0
    s_mov_b32 exec_hi, 0
    v_mov_b32 v188, 0x3f80
    v_mov_b32 v192, 0x3f80
    s_mov_b32 exec_lo, 0x10000000
    v_mov_b32 v196, 0x3f80
    v_mov_b32 v200, 0x3f80
    s_mov_b64 exec, -1
    s_lshl_b32 s61, s40, 21
    s_add_u32 s32, s20, s61
    s_addc_u32 s33, s21, 0
    s_mov_b32 s34, 2097152
    s_mov_b32 s35, 0x00020000
    v_lshlrev_b32 v1, 4, v0
    v_and_b32 v240, 0x33, v0
    v_bfe_u32 v241, v0, 2, 1
    v_lshl_add_u32 v240, v241, 3, v240
    v_bfe_u32 v241, v0, 3, 1
    v_lshl_add_u32 v240, v241, 2, v240
    v_lshlrev_b32 v15, 4, v240
    s_lshl_b32 s58, s55, 2
    s_lshr_b32 s59, s43, 2
    s_add_u32 s58, s58, s59
    s_mul_i32 s10, s58, 128
    s_lshl_b32 s58, s44, 2
    s_and_b32 s59, s43, 3
    s_add_u32 s58, s58, s59
    s_lshl_b32 s58, s58, 1
    s_add_u32 s58, s58, s54
    s_lshl_b32 s58, s58, 3
    s_add_u32 s10, s10, s58
    s_add_u32 s10, s10, 1048576
    s_lshl_b32 s58, s43, 1
    s_add_u32 s58, s58, s54
    s_lshl_b32 s59, s55, 6
    s_add_u32 s58, s58, s59
    s_lshl_b32 s45, s58, 13
    s_add_u32 s24, s45, 4096
    s_add_u32 s25, s45, 262144
    s_add_u32 s26, s45, 266240
    s_sub_u32 s58, s46, 4
    s_lshl_b32 s58, s58, 12
    s_add_u32 s58, s58, 122880
    v_add_u32 v23, s58, v1
    s_lshl_b32 s58, s46, 4
    s_add_u32 s58, s58, 139200
    v_mov_b32 v235, s58
    s_mov_b32 s53, 0x3e8b97f6
    s_mov_b32 s52, 0
    s_mov_b32 s51, 0
    s_cmp_lg_u32 s44, 0
    s_cbranch_scc1 P1_v1
P1_v0:
    s_waitcnt lgkmcnt(0)
    s_barrier
    ds_read_b128 v[128:131], v16 offset:0
    ds_read_b64_tr_b16 v[136:137], v20 offset:0
    ds_read_b64_tr_b16 v[138:139], v20 offset:1024
    ds_read_b128 v[132:135], v16 offset:4096
    ds_read_b64_tr_b16 v[140:141], v21 offset:0
    ds_read_b64_tr_b16 v[142:143], v21 offset:1024
    ds_read_b64_tr_b16 v[144:145], v22 offset:2048
    ds_read_b64_tr_b16 v[146:147], v22 offset:2560
.p2align 6
P1_loop0:
    v_mfma_f32_32x32x16_bf16 v[32:47], v[196:199], v[188:191], v[32:47]
    ds_read_b128 v[148:151], v17 offset:0
    ds_read_b64_tr_b16 v[156:157], v20 offset:6144
    v_mfma_f32_32x32x16_bf16 v[48:63], v[196:199], v[192:195], v[48:63]
    ds_read_b64_tr_b16 v[158:159], v20 offset:7168
    ds_read_b128 v[152:155], v17 offset:4096
    v_mfma_f32_32x32x16_bf16 v[64:79], v[200:203], v[188:191], v[64:79]
    ds_read_b64_tr_b16 v[160:161], v21 offset:6144
    ds_read_b64_tr_b16 v[162:163], v21 offset:7168
    v_mfma_f32_32x32x16_bf16 v[80:95], v[200:203], v[192:195], v[80:95]
    ds_read_b64_tr_b16 v[164:165], v22 offset:8192
    ds_read_b64_tr_b16 v[166:167], v22 offset:8704
    v_mfma_f32_32x32x16_bf16 v[96:111], v[204:207], v[188:191], v[96:111]
    s_add_u32 s52, s52, 1
    s_mov_b32 s51, 40960
    v_mfma_f32_32x32x16_bf16 v[112:127], v[204:207], v[192:195], v[112:127]
    s_waitcnt lgkmcnt(8)
    v_mfma_f32_32x32x16_bf16 v[32:47], v[136:139], v[128:131], v[32:47]
    ds_read_b128 v[168:171], v18 offset:0
    ds_read_b64_tr_b16 v[176:177], v20 offset:12288
    v_mfma_f32_32x32x16_bf16 v[48:63], v[136:139], v[132:135], v[48:63]
    ds_read_b64_tr_b16 v[178:179], v20 offset:13312
    ds_read_b128 v[172:175], v18 offset:4096
    v_mfma_f32_32x32x16_bf16 v[64:79], v[140:143], v[128:131], v[64:79]
    ds_read_b64_tr_b16 v[180:181], v21 offset:12288
    ds_read_b64_tr_b16 v[182:183], v21 offset:13312
    v_mfma_f32_32x32x16_bf16 v[80:95], v[140:143], v[132:135], v[80:95]
    ds_read_b64_tr_b16 v[184:185], v22 offset:14336
    ds_read_b64_tr_b16 v[186:187], v22 offset:14848
    v_mfma_f32_32x32x16_bf16 v[96:111], v[144:147], v[128:131], v[96:111]
    s_cmp_eq_u32 s52, 3
    s_cselect_b32 s51, 0xfffec000, s51
    v_mfma_f32_32x32x16_bf16 v[112:127], v[144:147], v[132:135], v[112:127]
    s_waitcnt lgkmcnt(8)
    v_mfma_f32_32x32x16_bf16 v[32:47], v[156:159], v[148:151], v[32:47]
    ds_read_b128 v[188:191], v19 offset:0
    ds_read_b64_tr_b16 v[196:197], v20 offset:18432
    v_mfma_f32_32x32x16_bf16 v[48:63], v[156:159], v[152:155], v[48:63]
    ds_read_b64_tr_b16 v[198:199], v20 offset:19456
    ds_read_b128 v[192:195], v19 offset:4096
    v_mfma_f32_32x32x16_bf16 v[64:79], v[160:163], v[148:151], v[64:79]
    ds_read_b64_tr_b16 v[200:201], v21 offset:18432
    ds_read_b64_tr_b16 v[202:203], v21 offset:19456
    v_mfma_f32_32x32x16_bf16 v[80:95], v[160:163], v[152:155], v[80:95]
    ds_read_b64_tr_b16 v[204:205], v22 offset:20480
    ds_read_b64_tr_b16 v[206:207], v22 offset:20992
    v_mfma_f32_32x32x16_bf16 v[96:111], v[164:167], v[148:151], v[96:111]
    v_add_u32 v16, s51, v16
    v_add_u32 v17, s51, v17
    v_add_u32 v18, s51, v18
    v_add_u32 v19, s51, v19
    v_mfma_f32_32x32x16_bf16 v[112:127], v[164:167], v[152:155], v[112:127]
    v_add_u32 v20, s51, v20
    v_add_u32 v21, s51, v21
    v_add_u32 v22, s51, v22
    s_waitcnt lgkmcnt(8)
    v_mfma_f32_32x32x16_bf16 v[32:47], v[176:179], v[168:171], v[32:47]
    v_mfma_f32_32x32x16_bf16 v[48:63], v[176:179], v[172:175], v[48:63]
    s_waitcnt lgkmcnt(0)
    v_mfma_f32_32x32x16_bf16 v[64:79], v[180:183], v[168:171], v[64:79]
    s_barrier
    v_mfma_f32_32x32x16_bf16 v[80:95], v[180:183], v[172:175], v[80:95]
    ds_read_b128 v[128:131], v16 offset:0
    ds_read_b64_tr_b16 v[136:137], v20 offset:0
    ds_read_b64_tr_b16 v[138:139], v20 offset:1024
    v_mfma_f32_32x32x16_bf16 v[96:111], v[184:187], v[168:171], v[96:111]
    ds_read_b128 v[132:135], v16 offset:4096
    ds_read_b64_tr_b16 v[140:141], v21 offset:0
    ds_read_b64_tr_b16 v[142:143], v21 offset:1024
    v_mfma_f32_32x32x16_bf16 v[112:127], v[184:187], v[172:175], v[112:127]
    ds_read_b64_tr_b16 v[144:145], v22 offset:2048
    ds_read_b64_tr_b16 v[146:147], v22 offset:2560
    s_cmp_lt_u32 s52, 4
    s_cbranch_scc1 P1_loop0
    v_mfma_f32_32x32x16_bf16 v[32:47], v[196:199], v[188:191], v[32:47]
    ds_read_b128 v[148:151], v17 offset:0
    ds_read_b64_tr_b16 v[156:157], v20 offset:6144
    v_mfma_f32_32x32x16_bf16 v[48:63], v[196:199], v[192:195], v[48:63]
    ds_read_b64_tr_b16 v[158:159], v20 offset:7168
    ds_read_b128 v[152:155], v17 offset:4096
    v_mfma_f32_32x32x16_bf16 v[64:79], v[200:203], v[188:191], v[64:79]
    ds_read_b64_tr_b16 v[160:161], v21 offset:6144
    ds_read_b64_tr_b16 v[162:163], v21 offset:7168
    v_mfma_f32_32x32x16_bf16 v[80:95], v[200:203], v[192:195], v[80:95]
    v_mfma_f32_32x32x16_bf16 v[96:111], v[204:207], v[188:191], v[96:111]
    v_mfma_f32_32x32x16_bf16 v[112:127], v[204:207], v[192:195], v[112:127]
    s_waitcnt lgkmcnt(6)
    v_mfma_f32_32x32x16_bf16 v[32:47], v[136:139], v[128:131], v[32:47]
    ds_read_b128 v[168:171], v18 offset:0
    ds_read_b64_tr_b16 v[176:177], v20 offset:12288
    v_mfma_f32_32x32x16_bf16 v[48:63], v[136:139], v[132:135], v[48:63]
    ds_read_b64_tr_b16 v[178:179], v20 offset:13312
    ds_read_b128 v[172:175], v18 offset:4096
    v_mfma_f32_32x32x16_bf16 v[64:79], v[140:143], v[128:131], v[64:79]
    ds_read_b64_tr_b16 v[180:181], v21 offset:12288
    ds_read_b64_tr_b16 v[182:183], v21 offset:13312
    v_mfma_f32_32x32x16_bf16 v[80:95], v[140:143], v[132:135], v[80:95]
    s_mov_b32 s51, 0xa000
    s_waitcnt lgkmcnt(6)
    v_mfma_f32_32x32x16_bf16 v[32:47], v[156:159], v[148:151], v[32:47]
    ds_read_b128 v[188:191], v19 offset:0
    ds_read_b64_tr_b16 v[196:197], v20 offset:18432
    v_mfma_f32_32x32x16_bf16 v[48:63], v[156:159], v[152:155], v[48:63]
    ds_read_b64_tr_b16 v[198:199], v20 offset:19456
    ds_read_b128 v[192:195], v19 offset:4096
    v_mfma_f32_32x32x16_bf16 v[64:79], v[160:163], v[148:151], v[64:79]
    ds_read_b64_tr_b16 v[200:201], v21 offset:18432
    ds_read_b64_tr_b16 v[202:203], v21 offset:19456
    v_mfma_f32_32x32x16_bf16 v[80:95], v[160:163], v[152:155], v[80:95]
    v_add_u32 v16, s51, v16
    v_add_u32 v17, s51, v17
    v_add_u32 v18, s51, v18
    v_add_u32 v19, s51, v19
    s_waitcnt lgkmcnt(6)
    v_mfma_f32_32x32x16_bf16 v[32:47], v[176:179], v[168:171], v[32:47]
    v_add_u32 v20, s51, v20
    v_add_u32 v21, s51, v21
    v_add_u32 v22, s51, v22
    s_waitcnt lgkmcnt(0)
    v_mfma_f32_32x32x16_bf16 v[48:63], v[176:179], v[172:175], v[48:63]
    s_barrier
    v_mfma_f32_32x32x16_bf16 v[64:79], v[180:183], v[168:171], v[64:79]
    ds_read_b128 v[128:131], v16 offset:0
    ds_read_b64_tr_b16 v[136:137], v20 offset:0
    ds_read_b64_tr_b16 v[138:139], v20 offset:1024
    v_mfma_f32_32x32x16_bf16 v[80:95], v[180:183], v[172:175], v[80:95]
    ds_read_b128 v[132:135], v16 offset:4096
    ds_read_b64_tr_b16 v[140:141], v21 offset:0
    ds_read_b64_tr_b16 v[142:143], v21 offset:1024
    v_mfma_f32_32x32x16_bf16 v[32:47], v[196:199], v[188:191], v[32:47]
    ds_read_b128 v[148:151], v17 offset:0
    ds_read_b64_tr_b16 v[156:157], v20 offset:6144
    v_mfma_f32_32x32x16_bf16 v[48:63], v[196:199], v[192:195], v[48:63]
    ds_read_b64_tr_b16 v[158:159], v20 offset:7168
    ds_read_b128 v[152:155], v17 offset:4096
    v_mfma_f32_32x32x16_bf16 v[64:79], v[200:203], v[188:191], v[64:79]
    ds_read_b64_tr_b16 v[160:161], v21 offset:6144
    ds_read_b64_tr_b16 v[162:163], v21 offset:7168
    v_mfma_f32_32x32x16_bf16 v[80:95], v[200:203], v[192:195], v[80:95]
    s_waitcnt lgkmcnt(6)
    v_mfma_f32_32x32x16_bf16 v[32:47], v[136:139], v[128:131], v[32:47]
    ds_read_b128 v[168:171], v18 offset:0
    ds_read_b64_tr_b16 v[176:177], v20 offset:12288
    v_mfma_f32_32x32x16_bf16 v[48:63], v[136:139], v[132:135], v[48:63]
    ds_read_b64_tr_b16 v[178:179], v20 offset:13312
    ds_read_b128 v[172:175], v18 offset:4096
    v_mfma_f32_32x32x16_bf16 v[64:79], v[140:143], v[128:131], v[64:79]
    ds_read_b64_tr_b16 v[180:181], v21 offset:12288
    ds_read_b64_tr_b16 v[182:183], v21 offset:13312
    v_mfma_f32_32x32x16_bf16 v[80:95], v[140:143], v[132:135], v[80:95]
    s_mov_b32 s51, 0xfffec000
    s_waitcnt lgkmcnt(6)
    v_mfma_f32_32x32x16_bf16 v[32:47], v[156:159], v[148:151], v[32:47]
    ds_read_b128 v[188:191], v19 offset:0
    ds_read_b64_tr_b16 v[196:197], v20 offset:18432
    v_mfma_f32_32x32x16_bf16 v[48:63], v[156:159], v[152:155], v[48:63]
    ds_read_b64_tr_b16 v[198:199], v20 offset:19456
    ds_read_b128 v[192:195], v19 offset:4096
    v_mfma_f32_32x32x16_bf16 v[64:79], v[160:163], v[148:151], v[64:79]
    ds_read_b64_tr_b16 v[200:201], v21 offset:18432
    ds_read_b64_tr_b16 v[202:203], v21 offset:19456
    v_mfma_f32_32x32x16_bf16 v[80:95], v[160:163], v[152:155], v[80:95]
    v_add_u32 v16, s51, v16
    v_add_u32 v17, s51, v17
    v_add_u32 v18, s51, v18
    v_add_u32 v19, s51, v19
    s_waitcnt lgkmcnt(6)
    v_mfma_f32_32x32x16_bf16 v[32:47], v[176:179], v[168:171], v[32:47]
    v_add_u32 v20, s51, v20
    v_add_u32 v21, s51, v21
    v_add_u32 v22, s51, v22
    s_waitcnt lgkmcnt(0)
    v_mfma_f32_32x32x16_bf16 v[48:63], v[176:179], v[172:175], v[48:63]
    s_barrier
    v_mfma_f32_32x32x16_bf16 v[64:79], v[180:183], v[168:171], v[64:79]
    ds_read_b128 v[128:131], v16 offset:0
    ds_read_b64_tr_b16 v[136:137], v20 offset:0
    ds_read_b64_tr_b16 v[138:139], v20 offset:1024
    v_mfma_f32_32x32x16_bf16 v[80:95], v[180:183], v[172:175], v[80:95]
    ds_read_b128 v[132:135], v16 offset:4096
    ds_read_b64_tr_b16 v[140:141], v21 offset:0
    ds_read_b64_tr_b16 v[142:143], v21 offset:1024
    v_mfma_f32_32x32x16_bf16 v[32:47], v[196:199], v[188:191], v[32:47]
    ds_read_b128 v[148:151], v17 offset:0
    ds_read_b64_tr_b16 v[156:157], v20 offset:6144
    ds_read_b64_tr_b16 v[158:159], v20 offset:7168
    v_mfma_f32_32x32x16_bf16 v[48:63], v[196:199], v[192:195], v[48:63]
    ds_read_b128 v[152:155], v17 offset:4096
    ds_read_b64_tr_b16 v[160:161], v21 offset:6144
    ds_read_b64_tr_b16 v[162:163], v21 offset:7168
    v_mfma_f32_32x32x16_bf16 v[64:79], v[200:203], v[188:191], v[64:79]
    ds_read_b128 v[168:171], v18 offset:0
    ds_read_b64_tr_b16 v[176:177], v20 offset:12288
    ds_read_b64_tr_b16 v[178:179], v20 offset:13312
    v_mfma_f32_32x32x16_bf16 v[80:95], v[200:203], v[192:195], v[80:95]
    ds_read_b128 v[172:175], v18 offset:4096
    ds_read_b64_tr_b16 v[180:181], v21 offset:12288
    ds_read_b64_tr_b16 v[182:183], v21 offset:13312
    ds_read_b128 v[188:191], v19 offset:0
    ds_read_b64_tr_b16 v[196:197], v20 offset:18432
    ds_read_b64_tr_b16 v[198:199], v20 offset:19456
    ds_read_b128 v[192:195], v19 offset:4096
    s_waitcnt lgkmcnt(14)
    v_mfma_f32_32x32x16_bf16 v[32:47], v[136:139], v[128:131], v[32:47]
    ds_read_b64_tr_b16 v[200:201], v21 offset:18432
    ds_read_b64_tr_b16 v[202:203], v21 offset:19456
    v_mfma_f32_32x32x16_bf16 v[48:63], v[136:139], v[132:135], v[48:63]
    s_waitcnt lgkmcnt(12)
    v_mfma_f32_32x32x16_bf16 v[32:47], v[156:159], v[148:151], v[32:47]
    v_mfma_f32_32x32x16_bf16 v[48:63], v[156:159], v[152:155], v[48:63]
    s_waitcnt lgkmcnt(6)
    v_mfma_f32_32x32x16_bf16 v[32:47], v[176:179], v[168:171], v[32:47]
    ds_read_b96 v[232:234], v235
    v_mfma_f32_32x32x16_bf16 v[48:63], v[176:179], v[172:175], v[48:63]
    s_waitcnt lgkmcnt(0)
    v_mfma_f32_32x32x16_bf16 v[32:47], v[196:199], v[188:191], v[32:47]
    v_readfirstlane_b32 s58, v234
    s_nop 0
    s_cmp_eq_u32 s58, 0
    s_cselect_b32 s6, 1, 0
    s_cselect_b64 vcc, -1, 0
    v_mfma_f32_32x32x16_bf16 v[48:63], v[196:199], v[192:195], v[48:63]
    s_nop 4
    v_mfma_f32_32x32x16_bf16 v[64:79], v[140:143], v[128:131], v[64:79]
    v_cvt_pk_bf16_f32 v32, v32, v33
    v_cvt_pk_bf16_f32 v33, v34, v35
    v_cvt_pk_bf16_f32 v34, v36, v37
    v_cvt_pk_bf16_f32 v35, v38, v39
    v_cvt_pk_bf16_f32 v36, v40, v41
    v_cvt_pk_bf16_f32 v37, v42, v43
    v_mfma_f32_32x32x16_bf16 v[64:79], v[160:163], v[148:151], v[64:79]
    s_cbranch_vccz L_wt000
    buffer_store_dwordx4 v[32:35], v15, s[32:35], s45 offen offset:0
L_st000:
    v_cvt_pk_bf16_f32 v38, v44, v45
    v_cvt_pk_bf16_f32 v39, v46, v47
    v_cvt_pk_bf16_f32 v48, v48, v49
    v_cvt_pk_bf16_f32 v49, v50, v51
    v_cvt_pk_bf16_f32 v50, v52, v53
    v_cvt_pk_bf16_f32 v51, v54, v55
    v_mfma_f32_32x32x16_bf16 v[64:79], v[180:183], v[168:171], v[64:79]
    v_cvt_pk_bf16_f32 v52, v56, v57
    v_cvt_pk_bf16_f32 v53, v58, v59
    v_cvt_pk_bf16_f32 v54, v60, v61
    v_cvt_pk_bf16_f32 v55, v62, v63
    v_mfma_f32_32x32x16_bf16 v[64:79], v[200:203], v[188:191], v[64:79]
    s_cbranch_vccz L_wt001
    buffer_store_dwordx4 v[36:39], v15, s[32:35], s45 offen offset:1024
L_st001:
    s_nop 4
    v_mfma_f32_32x32x16_bf16 v[80:95], v[140:143], v[132:135], v[80:95]
    s_barrier
    ds_read_b64_tr_b16 v[144:145], v22 offset:2048
    ds_read_b64_tr_b16 v[146:147], v22 offset:2560
    ds_read_b64_tr_b16 v[164:165], v22 offset:8192
    ds_read_b64_tr_b16 v[166:167], v22 offset:8704
    v_mfma_f32_32x32x16_bf16 v[80:95], v[160:163], v[152:155], v[80:95]
    s_cbranch_vccz L_wt010
    buffer_store_dwordx4 v[48:51], v15, s[32:35], s24 offen offset:0
L_st010:
    ds_read_b64_tr_b16 v[184:185], v22 offset:14336
    ds_read_b64_tr_b16 v[186:187], v22 offset:14848
    ds_read_b64_tr_b16 v[204:205], v22 offset:20480
    ds_read_b64_tr_b16 v[206:207], v22 offset:20992
    v_mfma_f32_32x32x16_bf16 v[80:95], v[180:183], v[172:175], v[80:95]
    v_cvt_pk_bf16_f32 v64, v64, v65
    v_cvt_pk_bf16_f32 v65, v66, v67
    v_cvt_pk_bf16_f32 v66, v68, v69
    v_cvt_pk_bf16_f32 v67, v70, v71
    v_cvt_pk_bf16_f32 v68, v72, v73
    v_cvt_pk_bf16_f32 v69, v74, v75
    v_mfma_f32_32x32x16_bf16 v[80:95], v[200:203], v[192:195], v[80:95]
    s_cbranch_vccz L_wt011
    buffer_store_dwordx4 v[52:55], v15, s[32:35], s24 offen offset:1024
L_st011:
    s_branch P1_done
P1_v1:
    v_add_u32 v15, 2048, v1
    s_waitcnt lgkmcnt(0)
    s_barrier
    ds_read_b128 v[128:131], v16 offset:0
    ds_read_b64_tr_b16 v[136:137], v20 offset:0
    ds_read_b64_tr_b16 v[138:139], v20 offset:1024
    ds_read_b128 v[132:135], v16 offset:4096
    ds_read_b64_tr_b16 v[140:141], v21 offset:0
    ds_read_b64_tr_b16 v[142:143], v21 offset:1024
    ds_read_b64_tr_b16 v[144:145], v22 offset:2048
    ds_read_b64_tr_b16 v[146:147], v22 offset:2560
.p2align 6
P1_loop1:
    v_mfma_f32_32x32x16_bf16 v[32:47], v[188:191], v[196:199], v[32:47]
    ds_read_b128 v[148:151], v17 offset:0
    ds_read_b64_tr_b16 v[156:157], v20 offset:6144
    v_mfma_f32_32x32x16_bf16 v[48:63], v[192:195], v[196:199], v[48:63]
    ds_read_b64_tr_b16 v[158:159], v20 offset:7168
    ds_read_b128 v[152:155], v17 offset:4096
    v_mfma_f32_32x32x16_bf16 v[64:79], v[188:191], v[200:203], v[64:79]
    ds_read_b64_tr_b16 v[160:161], v21 offset:6144
    ds_read_b64_tr_b16 v[162:163], v21 offset:7168
    v_mfma_f32_32x32x16_bf16 v[80:95], v[192:195], v[200:203], v[80:95]
    ds_read_b64_tr_b16 v[164:165], v22 offset:8192
    ds_read_b64_tr_b16 v[166:167], v22 offset:8704
    v_mfma_f32_32x32x16_bf16 v[96:111], v[204:207], v[188:191], v[96:111]
    s_add_u32 s52, s52, 1
    s_mov_b32 s51, 40960
    v_mfma_f32_32x32x16_bf16 v[112:127], v[204:207], v[192:195], v[112:127]
    s_waitcnt lgkmcnt(8)
    v_mfma_f32_32x32x16_bf16 v[32:47], v[128:131], v[136:139], v[32:47]
    ds_read_b128 v[168:171], v18 offset:0
    ds_read_b64_tr_b16 v[176:177], v20 offset:12288
    v_mfma_f32_32x32x16_bf16 v[48:63], v[132:135], v[136:139], v[48:63]
    ds_read_b64_tr_b16 v[178:179], v20 offset:13312
    ds_read_b128 v[172:175], v18 offset:4096
    v_mfma_f32_32x32x16_bf16 v[64:79], v[128:131], v[140:143], v[64:79]
    ds_read_b64_tr_b16 v[180:181], v21 offset:12288
    ds_read_b64_tr_b16 v[182:183], v21 offset:13312
    v_mfma_f32_32x32x16_bf16 v[80:95], v[132:135], v[140:143], v[80:95]
    ds_read_b64_tr_b16 v[184:185], v22 offset:14336
    ds_read_b64_tr_b16 v[186:187], v22 offset:14848
    v_mfma_f32_32x32x16_bf16 v[96:111], v[144:147], v[128:131], v[96:111]
    s_cmp_eq_u32 s52, 3
    s_cselect_b32 s51, 0xfffec000, s51
    v_mfma_f32_32x32x16_bf16 v[112:127], v[144:147], v[132:135], v[112:127]
    s_waitcnt lgkmcnt(8)
    v_mfma_f32_32x32x16_bf16 v[32:47], v[148:151], v[156:159], v[32:47]
    ds_read_b128 v[188:191], v19 offset:0
    ds_read_b64_tr_b16 v[196:197], v20 offset:18432
    v_mfma_f32_32x32x16_bf16 v[48:63], v[152:155], v[156:159], v[48:63]
    ds_read_b64_tr_b16 v[198:199], v20 offset:19456
    ds_read_b128 v[192:195], v19 offset:4096
    v_mfma_f32_32x32x16_bf16 v[64:79], v[148:151], v[160:163], v[64:79]
    ds_read_b64_tr_b16 v[200:201], v21 offset:18432
    ds_read_b64_tr_b16 v[202:203], v21 offset:19456
    v_mfma_f32_32x32x16_bf16 v[80:95], v[152:155], v[160:163], v[80:95]
    ds_read_b64_tr_b16 v[204:205], v22 offset:20480
    ds_read_b64_tr_b16 v[206:207], v22 offset:20992
    v_mfma_f32_32x32x16_bf16 v[96:111], v[164:167], v[148:151], v[96:111]
    v_add_u32 v16, s51, v16
    v_add_u32 v17, s51, v17
    v_add_u32 v18, s51, v18
    v_add_u32 v19, s51, v19
    v_mfma_f32_32x32x16_bf16 v[112:127], v[164:167], v[152:155], v[112:127]
    v_add_u32 v20, s51, v20
    v_add_u32 v21, s51, v21
    v_add_u32 v22, s51, v22
    s_waitcnt lgkmcnt(8)
    v_mfma_f32_32x32x16_bf16 v[32:47], v[168:171], v[176:179], v[32:47]
    v_mfma_f32_32x32x16_bf16 v[48:63], v[172:175], v[176:179], v[48:63]
    s_waitcnt lgkmcnt(0)
    v_mfma_f32_32x32x16_bf16 v[64:79], v[168:171], v[180:183], v[64:79]
    s_barrier
    v_mfma_f32_32x32x16_bf16 v[80:95], v[172:175], v[180:183], v[80:95]
    ds_read_b128 v[128:131], v16 offset:0
    ds_read_b64_tr_b16 v[136:137], v20 offset:0
    ds_read_b64_tr_b16 v[138:139], v20 offset:1024
    v_mfma_f32_32x32x16_bf16 v[96:111], v[184:187], v[168:171], v[96:111]
    ds_read_b128 v[132:135], v16 offset:4096
    ds_read_b64_tr_b16 v[140:141], v21 offset:0
    ds_read_b64_tr_b16 v[142:143], v21 offset:1024
    v_mfma_f32_32x32x16_bf16 v[112:127], v[184:187], v[172:175], v[112:127]
    ds_read_b64_tr_b16 v[144:145], v22 offset:2048
    ds_read_b64_tr_b16 v[146:147], v22 offset:2560
    s_cmp_lt_u32 s52, 4
    s_cbranch_scc1 P1_loop1
    v_mfma_f32_32x32x16_bf16 v[32:47], v[188:191], v[196:199], v[32:47]
    ds_read_b128 v[148:151], v17 offset:0
    ds_read_b64_tr_b16 v[156:157], v20 offset:6144
    v_mfma_f32_32x32x16_bf16 v[48:63], v[192:195], v[196:199], v[48:63]
    ds_read_b64_tr_b16 v[158:159], v20 offset:7168
    ds_read_b128 v[152:155], v17 offset:4096
    v_mfma_f32_32x32x16_bf16 v[64:79], v[188:191], v[200:203], v[64:79]
    ds_read_b64_tr_b16 v[160:161], v21 offset:6144
    ds_read_b64_tr_b16 v[162:163], v21 offset:7168
    v_mfma_f32_32x32x16_bf16 v[80:95], v[192:195], v[200:203], v[80:95]
    v_mfma_f32_32x32x16_bf16 v[96:111], v[204:207], v[188:191], v[96:111]
    v_mfma_f32_32x32x16_bf16 v[112:127], v[204:207], v[192:195], v[112:127]
    s_waitcnt lgkmcnt(6)
    v_mfma_f32_32x32x16_bf16 v[32:47], v[128:131], v[136:139], v[32:47]
    ds_read_b128 v[168:171], v18 offset:0
    ds_read_b64_tr_b16 v[176:177], v20 offset:12288
    v_mfma_f32_32x32x16_bf16 v[48:63], v[132:135], v[136:139], v[48:63]
    ds_read_b64_tr_b16 v[178:179], v20 offset:13312
    ds_read_b128 v[172:175], v18 offset:4096
    v_mfma_f32_32x32x16_bf16 v[64:79], v[128:131], v[140:143], v[64:79]
    ds_read_b64_tr_b16 v[180:181], v21 offset:12288
    ds_read_b64_tr_b16 v[182:183], v21 offset:13312
    v_mfma_f32_32x32x16_bf16 v[80:95], v[132:135], v[140:143], v[80:95]
    s_mov_b32 s51, 0xa000
    s_waitcnt lgkmcnt(6)
    v_mfma_f32_32x32x16_bf16 v[32:47], v[148:151], v[156:159], v[32:47]
    ds_read_b128 v[188:191], v19 offset:0
    ds_read_b64_tr_b16 v[196:197], v20 offset:18432
    v_mfma_f32_32x32x16_bf16 v[48:63], v[152:155], v[156:159], v[48:63]
    ds_read_b64_tr_b16 v[198:199], v20 offset:19456
    ds_read_b128 v[192:195], v19 offset:4096
    v_mfma_f32_32x32x16_bf16 v[64:79], v[148:151], v[160:163], v[64:79]
    ds_read_b64_tr_b16 v[200:201], v21 offset:18432
    ds_read_b64_tr_b16 v[202:203], v21 offset:19456
    v_mfma_f32_32x32x16_bf16 v[80:95], v[152:155], v[160:163], v[80:95]
    v_add_u32 v16, s51, v16
    v_add_u32 v17, s51, v17
    v_add_u32 v18, s51, v18
    v_add_u32 v19, s51, v19
    s_waitcnt lgkmcnt(6)
    v_mfma_f32_32x32x16_bf16 v[32:47], v[168:171], v[176:179], v[32:47]
    v_add_u32 v20, s51, v20
    v_add_u32 v21, s51, v21
    v_add_u32 v22, s51, v22
    s_waitcnt lgkmcnt(0)
    v_mfma_f32_32x32x16_bf16 v[48:63], v[172:175], v[176:179], v[48:63]
    s_barrier
    v_mfma_f32_32x32x16_bf16 v[64:79], v[168:171], v[180:183], v[64:79]
    ds_read_b128 v[128:131], v16 offset:0
    ds_read_b64_tr_b16 v[136:137], v20 offset:0
    ds_read_b64_tr_b16 v[138:139], v20 offset:1024
    v_mfma_f32_32x32x16_bf16 v[80:95], v[172:175], v[180:183], v[80:95]
    ds_read_b128 v[132:135], v16 offset:4096
    ds_read_b64_tr_b16 v[140:141], v21 offset:0
    ds_read_b64_tr_b16 v[142:143], v21 offset:1024
    v_mfma_f32_32x32x16_bf16 v[32:47], v[188:191], v[196:199], v[32:47]
    ds_read_b128 v[148:151], v17 offset:0
    ds_read_b64_tr_b16 v[156:157], v20 offset:6144
    v_mfma_f32_32x32x16_bf16 v[48:63], v[192:195], v[196:199], v[48:63]
    ds_read_b64_tr_b16 v[158:159], v20 offset:7168
    ds_read_b128 v[152:155], v17 offset:4096
    v_mfma_f32_32x32x16_bf16 v[64:79], v[188:191], v[200:203], v[64:79]
    ds_read_b64_tr_b16 v[160:161], v21 offset:6144
    ds_read_b64_tr_b16 v[162:163], v21 offset:7168
    v_mfma_f32_32x32x16_bf16 v[80:95], v[192:195], v[200:203], v[80:95]
    s_waitcnt lgkmcnt(6)
    v_mfma_f32_32x32x16_bf16 v[32:47], v[128:131], v[136:139], v[32:47]
    ds_read_b128 v[168:171], v18 offset:0
    ds_read_b64_tr_b16 v[176:177], v20 offset:12288
    v_mfma_f32_32x32x16_bf16 v[48:63], v[132:135], v[136:139], v[48:63]
    ds_read_b64_tr_b16 v[178:179], v20 offset:13312
    ds_read_b128 v[172:175], v18 offset:4096
    v_mfma_f32_32x32x16_bf16 v[64:79], v[128:131], v[140:143], v[64:79]
    ds_read_b64_tr_b16 v[180:181], v21 offset:12288
    ds_read_b64_tr_b16 v[182:183], v21 offset:13312
    v_mfma_f32_32x32x16_bf16 v[80:95], v[132:135], v[140:143], v[80:95]
    s_mov_b32 s51, 0xfffec000
    s_waitcnt lgkmcnt(6)
    v_mfma_f32_32x32x16_bf16 v[32:47], v[148:151], v[156:159], v[32:47]
    ds_read_b128 v[188:191], v19 offset:0
    ds_read_b64_tr_b16 v[196:197], v20 offset:18432
    v_mfma_f32_32x32x16_bf16 v[48:63], v[152:155], v[156:159], v[48:63]
    ds_read_b64_tr_b16 v[198:199], v20 offset:19456
    ds_read_b128 v[192:195], v19 offset:4096
    v_mfma_f32_32x32x16_bf16 v[64:79], v[148:151], v[160:163], v[64:79]
    ds_read_b64_tr_b16 v[200:201], v21 offset:18432
    ds_read_b64_tr_b16 v[202:203], v21 offset:19456
    v_mfma_f32_32x32x16_bf16 v[80:95], v[152:155], v[160:163], v[80:95]
    v_add_u32 v16, s51, v16
    v_add_u32 v17, s51, v17
    v_add_u32 v18, s51, v18
    v_add_u32 v19, s51, v19
    s_waitcnt lgkmcnt(6)
    v_mfma_f32_32x32x16_bf16 v[32:47], v[168:171], v[176:179], v[32:47]
    v_add_u32 v20, s51, v20
    v_add_u32 v21, s51, v21
    v_add_u32 v22, s51, v22
    s_waitcnt lgkmcnt(0)
    v_mfma_f32_32x32x16_bf16 v[48:63], v[172:175], v[176:179], v[48:63]
    s_barrier
    v_mfma_f32_32x32x16_bf16 v[64:79], v[168:171], v[180:183], v[64:79]
    ds_read_b128 v[128:131], v16 offset:0
    ds_read_b64_tr_b16 v[136:137], v20 offset:0
    ds_read_b64_tr_b16 v[138:139], v20 offset:1024
    v_mfma_f32_32x32x16_bf16 v[80:95], v[172:175], v[180:183], v[80:95]
    ds_read_b128 v[132:135], v16 offset:4096
    ds_read_b64_tr_b16 v[140:141], v21 offset:0
    ds_read_b64_tr_b16 v[142:143], v21 offset:1024
    v_mfma_f32_32x32x16_bf16 v[32:47], v[188:191], v[196:199], v[32:47]
    ds_read_b128 v[148:151], v17 offset:0
    ds_read_b64_tr_b16 v[156:157], v20 offset:6144
    ds_read_b64_tr_b16 v[158:159], v20 offset:7168
    v_mfma_f32_32x32x16_bf16 v[48:63], v[192:195], v[196:199], v[48:63]
    ds_read_b128 v[152:155], v17 offset:4096
    ds_read_b64_tr_b16 v[160:161], v21 offset:6144
    ds_read_b64_tr_b16 v[162:163], v21 offset:7168
    v_mfma_f32_32x32x16_bf16 v[64:79], v[188:191], v[200:203], v[64:79]
    ds_read_b128 v[168:171], v18 offset:0
    ds_read_b64_tr_b16 v[176:177], v20 offset:12288
    ds_read_b64_tr_b16 v[178:179], v20 offset:13312
    v_mfma_f32_32x32x16_bf16 v[80:95], v[192:195], v[200:203], v[80:95]
    ds_read_b128 v[172:175], v18 offset:4096
    ds_read_b64_tr_b16 v[180:181], v21 offset:12288
    ds_read_b64_tr_b16 v[182:183], v21 offset:13312
    ds_read_b128 v[188:191], v19 offset:0
    ds_read_b64_tr_b16 v[196:197], v20 offset:18432
    ds_read_b64_tr_b16 v[198:199], v20 offset:19456
    ds_read_b128 v[192:195], v19 offset:4096
    s_waitcnt lgkmcnt(14)
    v_mfma_f32_32x32x16_bf16 v[32:47], v[128:131], v[136:139], v[32:47]
    ds_read_b64_tr_b16 v[200:201], v21 offset:18432
    ds_read_b64_tr_b16 v[202:203], v21 offset:19456
    v_mfma_f32_32x32x16_bf16 v[48:63], v[132:135], v[136:139], v[48:63]
    s_waitcnt lgkmcnt(12)
    v_mfma_f32_32x32x16_bf16 v[32:47], v[148:151], v[156:159], v[32:47]
    v_mfma_f32_32x32x16_bf16 v[48:63], v[152:155], v[156:159], v[48:63]
    s_waitcnt lgkmcnt(6)
    v_mfma_f32_32x32x16_bf16 v[32:47], v[168:171], v[176:179], v[32:47]
    ds_read_b96 v[232:234], v235
    v_mfma_f32_32x32x16_bf16 v[48:63], v[172:175], v[176:179], v[48:63]
    s_waitcnt lgkmcnt(0)
    v_mfma_f32_32x32x16_bf16 v[32:47], v[188:191], v[196:199], v[32:47]
    v_readfirstlane_b32 s58, v234
    s_nop 0
    s_cmp_eq_u32 s58, 0
    s_cselect_b32 s6, 1, 0
    s_cselect_b64 vcc, -1, 0
    v_mfma_f32_32x32x16_bf16 v[48:63], v[192:195], v[196:199], v[48:63]
    s_nop 4
    v_mfma_f32_32x32x16_bf16 v[64:79], v[128:131], v[140:143], v[64:79]
    v_cvt_pk_bf16_f32 v32, v32, v33
    v_cvt_pk_bf16_f32 v33, v34, v35
    v_cvt_pk_bf16_f32 v34, v36, v37
    v_cvt_pk_bf16_f32 v35, v38, v39
    v_cvt_pk_bf16_f32 v36, v40, v41
    v_cvt_pk_bf16_f32 v37, v42, v43
    v_mfma_f32_32x32x16_bf16 v[64:79], v[148:151], v[160:163], v[64:79]
    s_cbranch_vccz L_wt100
    buffer_store_dwordx4 v[32:35], v15, s[32:35], s45 offen offset:0
L_st100:
    v_cvt_pk_bf16_f32 v38, v44, v45
    v_cvt_pk_bf16_f32 v39, v46, v47
    v_cvt_pk_bf16_f32 v48, v48, v49
    v_cvt_pk_bf16_f32 v49, v50, v51
    v_cvt_pk_bf16_f32 v50, v52, v53
    v_cvt_pk_bf16_f32 v51, v54, v55
    v_mfma_f32_32x32x16_bf16 v[64:79], v[168:171], v[180:183], v[64:79]
    v_cvt_pk_bf16_f32 v52, v56, v57
    v_cvt_pk_bf16_f32 v53, v58, v59
    v_cvt_pk_bf16_f32 v54, v60, v61
    v_cvt_pk_bf16_f32 v55, v62, v63
    v_mfma_f32_32x32x16_bf16 v[64:79], v[188:191], v[200:203], v[64:79]
    s_cbranch_vccz L_wt101
    buffer_store_dwordx4 v[36:39], v15, s[32:35], s45 offen offset:1024
L_st101:
    s_nop 4
    v_mfma_f32_32x32x16_bf16 v[80:95], v[132:135], v[140:143], v[80:95]
    s_barrier
    ds_read_b64_tr_b16 v[144:145], v22 offset:2048
    ds_read_b64_tr_b16 v[146:147], v22 offset:2560
    ds_read_b64_tr_b16 v[164:165], v22 offset:8192
    ds_read_b64_tr_b16 v[166:167], v22 offset:8704
    v_mfma_f32_32x32x16_bf16 v[80:95], v[152:155], v[160:163], v[80:95]
    s_cbranch_vccz L_wt110
    buffer_store_dwordx4 v[48:51], v15, s[32:35], s24 offen offset:0
L_st110:
    ds_read_b64_tr_b16 v[184:185], v22 offset:14336
    ds_read_b64_tr_b16 v[186:187], v22 offset:14848
    ds_read_b64_tr_b16 v[204:205], v22 offset:20480
    ds_read_b64_tr_b16 v[206:207], v22 offset:20992
    v_mfma_f32_32x32x16_bf16 v[80:95], v[172:175], v[180:183], v[80:95]
    v_cvt_pk_bf16_f32 v64, v64, v65
    v_cvt_pk_bf16_f32 v65, v66, v67
    v_cvt_pk_bf16_f32 v66, v68, v69
    v_cvt_pk_bf16_f32 v67, v70, v71
    v_cvt_pk_bf16_f32 v68, v72, v73
    v_cvt_pk_bf16_f32 v69, v74, v75
    v_mfma_f32_32x32x16_bf16 v[80:95], v[192:195], v[200:203], v[80:95]
    s_cbranch_vccz L_wt111
    buffer_store_dwordx4 v[52:55], v15, s[32:35], s24 offen offset:1024
L_st111:
P1_done:
    s_waitcnt lgkmcnt(6)
    v_mfma_f32_32x32x16_bf16 v[96:111], v[144:147], v[128:131], v[96:111]
    v_cvt_pk_bf16_f32 v70, v76, v77
    v_cvt_pk_bf16_f32 v71, v78, v79
    v_mfma_f32_32x32x16_bf16 v[112:127], v[144:147], v[132:135], v[112:127]
    s_cbranch_vccz L_wtc20
    buffer_store_dwordx4 v[64:67], v15, s[32:35], s25 offen offset:0
L_stc20:
    ds_read_b128 v[128:131], v16 offset:40960
    ds_read_b64_tr_b16 v[144:145], v22 offset:43008
    ds_read_b64_tr_b16 v[146:147], v22 offset:43520
    ds_read_b128 v[132:135], v16 offset:45056
    v_cvt_pk_bf16_f32 v80, v80, v81
    v_cvt_pk_bf16_f32 v81, v82, v83
    s_cmp_eq_u32 s42, 0
    s_cselect_b32 s36, s8, s14
    s_waitcnt lgkmcnt(8)
    v_mfma_f32_32x32x16_bf16 v[96:111], v[164:167], v[148:151], v[96:111]
    v_cvt_pk_bf16_f32 v82, v84, v85
    v_cvt_pk_bf16_f32 v83, v86, v87
    v_cvt_pk_bf16_f32 v84, v88, v89
    v_cvt_pk_bf16_f32 v85, v90, v91
    v_cvt_pk_bf16_f32 v86, v92, v93
    v_cvt_pk_bf16_f32 v87, v94, v95
    v_mfma_f32_32x32x16_bf16 v[112:127], v[164:167], v[152:155], v[112:127]
    s_cbranch_vccz L_wtc21
    buffer_store_dwordx4 v[68:71], v15, s[32:35], s25 offen offset:1024
L_stc21:
    ds_read_b128 v[148:151], v17 offset:40960
    ds_read_b64_tr_b16 v[164:165], v22 offset:49152
    ds_read_b64_tr_b16 v[166:167], v22 offset:49664
    ds_read_b128 v[152:155], v17 offset:45056
    s_cselect_b32 s37, s9, s15
    s_mov_b32 s38, 401408
    s_waitcnt lgkmcnt(10)
    v_mfma_f32_32x32x16_bf16 v[96:111], v[184:187], v[168:171], v[96:111]
    s_mov_b32 s39, 0x00020000
    s_mov_b32 s64, s16
    s_mov_b32 s65, s17
    s_mov_b32 s66, 3670016
    s_mov_b32 s67, 0x00020000
    s_lshl_b32 s61, s42, 21
    v_mfma_f32_32x32x16_bf16 v[112:127], v[184:187], v[172:175], v[112:127]
    s_cbranch_vccz L_wtc30
    buffer_store_dwordx4 v[80:83], v15, s[32:35], s26 offen offset:0
L_stc30:
    ds_read_b128 v[168:171], v18 offset:40960
    ds_read_b64_tr_b16 v[184:185], v22 offset:55296
    ds_read_b64_tr_b16 v[186:187], v22 offset:55808
    ds_read_b128 v[172:175], v18 offset:45056
    s_add_u32 s61, s61, 16777216
    s_add_u32 s12, s20, s61
    s_waitcnt lgkmcnt(12)
    v_mfma_f32_32x32x16_bf16 v[96:111], v[204:207], v[188:191], v[96:111]
    s_addc_u32 s13, s21, 0
    s_mov_b32 s14, 2097152
    s_mov_b32 s15, 0x00020000
    s_mov_b32 s50, 1
    s_and_b32 s48, s43, 1
    s_xor_b32 s48, s48, 1
    v_mfma_f32_32x32x16_bf16 v[112:127], v[204:207], v[192:195], v[112:127]
    s_cbranch_vccz L_wtc31
    buffer_store_dwordx4 v[84:87], v15, s[32:35], s26 offen offset:1024
L_stc31:
    ds_read_b128 v[188:191], v19 offset:40960
    ds_read_b64_tr_b16 v[204:205], v22 offset:61440
    ds_read_b64_tr_b16 v[206:207], v22 offset:61952
    ds_read_b128 v[192:195], v19 offset:45056
    s_lshl_b32 s47, s44, 1
    s_add_u32 s47, s47, s48
    s_waitcnt lgkmcnt(12)
    v_mfma_f32_32x32x16_bf16 v[96:111], v[144:147], v[128:131], v[96:111]
    s_lshl_b32 s61, s47, 18
    s_add_u32 s72, s32, s61
    s_addc_u32 s73, s33, 0
    s_mov_b32 s74, 262144
    s_mov_b32 s75, 0x00020000
    s_and_b32 s56, s46, 3
    v_mfma_f32_32x32x16_bf16 v[112:127], v[144:147], v[132:135], v[112:127]
    v_add_u32 v16, 40960, v16
    v_add_u32 v22, 40960, v22
    ds_read_b128 v[128:131], v16 offset:40960
    ds_read_b64_tr_b16 v[144:145], v22 offset:43008
    ds_read_b64_tr_b16 v[146:147], v22 offset:43520
    ds_read_b128 v[132:135], v16 offset:45056
    s_lshl_b32 s16, s56, 16
    v_and_b32 v240, 15, v0
    s_waitcnt lgkmcnt(12)
    v_mfma_f32_32x32x16_bf16 v[96:111], v[164:167], v[148:151], v[96:111]
    v_lshlrev_b32 v240, 3, v240
    s_lshl_b32 s58, s44, 2
    s_add_u32 s58, s58, s56
    s_mul_i32 s58, s58, 128
    s_add_u32 s58, s58, 1048576
    v_add_u32 v4, s58, v240
    v_mfma_f32_32x32x16_bf16 v[112:127], v[164:167], v[152:155], v[112:127]
    v_add_u32 v17, 40960, v17
    ds_read_b128 v[148:151], v17 offset:40960
    ds_read_b64_tr_b16 v[164:165], v22 offset:49152
    ds_read_b64_tr_b16 v[166:167], v22 offset:49664
    ds_read_b128 v[152:155], v17 offset:45056
    v_lshlrev_b32 v1, 4, v0
    v_lshlrev_b32 v6, 3, v0
    s_waitcnt lgkmcnt(12)
    v_mfma_f32_32x32x16_bf16 v[96:111], v[184:187], v[168:171], v[96:111]
    v_lshlrev_b32 v240, 2, v0
    v_mov_b32 v2, 0xdddddddd
    s_lshl_b32 s59, s56, 8
    s_add_u32 s59, s59, 107520
    v_add_u32 v7, s59, v240
    s_mul_i32 s59, s56, 12288
    v_mfma_f32_32x32x16_bf16 v[112:127], v[184:187], v[172:175], v[112:127]
    v_add_u32 v18, 40960, v18
    ds_read_b128 v[168:171], v18 offset:40960
    ds_read_b64_tr_b16 v[184:185], v22 offset:55296
    ds_read_b64_tr_b16 v[186:187], v22 offset:55808
    ds_read_b128 v[172:175], v18 offset:45056
    s_add_u32 s59, s59, 113664
    v_add_u32 v14, s59, v1
    s_waitcnt lgkmcnt(12)
    v_mfma_f32_32x32x16_bf16 v[96:111], v[204:207], v[188:191], v[96:111]
    s_add_u32 s58, s56, 1
    s_and_b32 s58, s58, 3
    s_lshl_b32 s59, s58, 8
    s_add_u32 s59, s59, 107520
    v_add_u32 v8, s59, v240
    s_mul_i32 s59, s58, 12288
    v_mfma_f32_32x32x16_bf16 v[112:127], v[204:207], v[192:195], v[112:127]
    v_add_u32 v19, 40960, v19
    ds_read_b128 v[188:191], v19 offset:40960
    ds_read_b64_tr_b16 v[204:205], v22 offset:61440
    ds_read_b64_tr_b16 v[206:207], v22 offset:61952
    ds_read_b128 v[192:195], v19 offset:45056
    s_add_u32 s59, s59, 113664
    v_add_u32 v11, s59, v1
    s_waitcnt lgkmcnt(12)
    v_mfma_f32_32x32x16_bf16 v[96:111], v[144:147], v[128:131], v[96:111]
    s_add_u32 s58, s56, 2
    s_and_b32 s58, s58, 3
    s_lshl_b32 s59, s58, 8
    s_add_u32 s59, s59, 107520
    v_add_u32 v9, s59, v240
    s_mul_i32 s59, s58, 12288
    v_mfma_f32_32x32x16_bf16 v[112:127], v[144:147], v[132:135], v[112:127]
    s_add_u32 s59, s59, 117760
    v_add_u32 v12, s59, v1
    s_add_u32 s58, s56, 3
    s_and_b32 s58, s58, 3
    s_lshl_b32 s59, s58, 8
    s_add_u32 s59, s59, 107520
    s_waitcnt lgkmcnt(8)
    v_mfma_f32_32x32x16_bf16 v[96:111], v[164:167], v[148:151], v[96:111]
    v_add_u32 v10, s59, v240
    s_mul_i32 s59, s58, 12288
    s_add_u32 s59, s59, 121856
    v_add_u32 v13, s59, v1
    v_mov_b32 v3, 163812
    v_mov_b32 v5, 1
    s_waitcnt lgkmcnt(4)
    v_mfma_f32_32x32x16_bf16 v[96:111], v[184:187], v[168:171], v[96:111]
    s_lshl_b32 s9, s43, 2
    s_add_u32 s9, s9, s56
    s_lshl_b32 s58, s49, 2
    s_lshr_b32 s58, 0x2640, s58
    s_and_b32 s58, s58, 7
    s_add_u32 s58, s58, s44
    s_waitcnt lgkmcnt(0)
    v_mfma_f32_32x32x16_bf16 v[96:111], v[204:207], v[188:191], v[96:111]
    s_lshl_b32 s59, s48, 3
    s_add_u32 s58, s58, s59
    s_lshl_b32 s59, s9, 4
    s_add_u32 s59, s59, s58
    s_mul_i32 s19, s59, 1792
    s_mul_i32 s22, s59, 32
    v_mfma_f32_32x32x16_bf16 v[112:127], v[164:167], v[152:155], v[112:127]
    s_mov_b32 s63, 4194304
L_nonceC:
    v_readfirstlane_b32 s76, v232
    v_readfirstlane_b32 s77, v233
    s_cmp_lg_u32 s76, 0
    s_cselect_b32 s61, s77, 0
    s_cmp_lg_u32 s61, 0
    s_cbranch_scc0 L_nonce_retryC
    s_mov_b64 exec, 1
    s_cmp_eq_u32 s6, 0
    s_waitcnt vmcnt(0)
    s_cbranch_scc1 L_f1wt
    buffer_store_dwordx2 v[232:233], off, s[32:35], s10
L_f1st:
    s_mov_b64 exec, -1
    v_mfma_f32_32x32x16_bf16 v[112:127], v[184:187], v[172:175], v[112:127]
    v_mul_f32 v96, s53, v96
    v_mul_f32 v97, s53, v97
    v_mul_f32 v98, s53, v98
    v_mul_f32 v99, s53, v99
    v_mul_f32 v100, s53, v100
    v_mul_f32 v101, s53, v101
    v_mfma_f32_32x32x16_bf16 v[112:127], v[204:207], v[192:195], v[112:127]
    v_mul_f32 v102, s53, v102
    v_mul_f32 v103, s53, v103
    v_mul_f32 v104, s53, v104
    v_mul_f32 v105, s53, v105
    v_mul_f32 v106, s53, v106
    v_mul_f32 v107, s53, v107
    v_mov_b32 v3, 163812
    v_mov_b32 v5, 1
    v_mul_f32 v108, s53, v108
    v_mul_f32 v109, s53, v109
    v_mul_f32 v110, s53, v110
    v_mul_f32 v111, s53, v111
    v_cvt_pk_bf16_f32 v96, v96, v97
    v_cvt_pk_bf16_f32 v97, v98, v99
    v_cvt_pk_bf16_f32 v98, v100, v101
    v_cvt_pk_bf16_f32 v99, v102, v103
    v_cvt_pk_bf16_f32 v100, v104, v105
    v_cvt_pk_bf16_f32 v101, v106, v107
    v_cvt_pk_bf16_f32 v102, v108, v109
    v_cvt_pk_bf16_f32 v103, v110, v111
    ds_write_b128 v23, v[96:99] offset:0
    ds_write_b128 v23, v[100:103] offset:1024
    v_mul_f32 v112, s53, v112
    v_mul_f32 v113, s53, v113
    v_mul_f32 v114, s53, v114
    v_mul_f32 v115, s53, v115
    v_mul_f32 v116, s53, v116
    v_mul_f32 v117, s53, v117
    v_mul_f32 v118, s53, v118
    v_mul_f32 v119, s53, v119
    v_mul_f32 v120, s53, v120
    v_mul_f32 v121, s53, v121
    v_mul_f32 v122, s53, v122
    v_mul_f32 v123, s53, v123
    v_mul_f32 v124, s53, v124
    v_mul_f32 v125, s53, v125
    v_mul_f32 v126, s53, v126
    v_mul_f32 v127, s53, v127
    v_cvt_pk_bf16_f32 v112, v112, v113
    v_cvt_pk_bf16_f32 v113, v114, v115
    v_cvt_pk_bf16_f32 v114, v116, v117
    v_cvt_pk_bf16_f32 v115, v118, v119
    v_cvt_pk_bf16_f32 v116, v120, v121
    v_cvt_pk_bf16_f32 v117, v122, v123
    v_cvt_pk_bf16_f32 v118, v124, v125
    v_cvt_pk_bf16_f32 v119, v126, v127
    ds_write_b128 v23, v[112:115] offset:2048
    ds_write_b128 v23, v[116:119] offset:3072
    s_mov_b64 exec, 1
    ds_add_u32 v3, v5 offset:4
    s_mov_b64 exec, -1
    s_setprio 1
    s_add_u32 s22, s22, 1835008
    s_lshl_b32 s58, s49, 3
    s_lshr_b32 s59, s41, 2
    s_add_u32 s58, s58, s59
    s_and_b32 s59, s58, 2
    s_xor_b32 s59, s59, 2
    s_lshl_b32 s59, s59, 2
    s_lshl_b32 s58, s58, 5
    s_add_u32 s58, s58, s59
    s_and_b32 s59, s56, 1
    s_mul_i32 s51, s59, 14336
    s_lshl_b32 s59, s59, 4
    s_add_u32 s58, s58, s59
    s_and_b32 s59, s56, 2
    s_lshl_b32 s59, s59, 1
    s_add_u32 s58, s58, s59
    v_and_b32 v163, 3, v0
    v_add_u32 v163, s58, v163
    v_mul_u32_u24 v163, 32, v163
    v_add_u32 v163, 1835008, v163
    s_mul_i32 s43, s58, 1792
    s_add_u32 s57, s43, 4096
    s_mul_i32 s59, s59, 1792
    s_add_u32 s51, s51, s59
    s_add_u32 s51, s51, 86016
    s_lshl_b32 s59, s56, 2
    s_add_u32 s59, s59, 163824
    v_mov_b32 v164, s59
    v_mov_b32 v165, 163808
    v_mov_b32 v112, 0
    v_mov_b32 v113, 0
    v_mov_b32 v114, 0
    v_mov_b32 v115, 0
    s_nop 1
    v_mfma_f32_32x32x16_bf16 v[48:63], v[112:115], v[112:115], 0
    v_mfma_f32_32x32x16_bf16 v[64:79], v[112:115], v[112:115], 0
    v_mfma_f32_32x32x16_bf16 v[80:95], v[112:115], v[112:115], 0
    v_mfma_f32_32x32x16_bf16 v[96:111], v[112:115], v[112:115], 0
    s_add_u32 s58, s72, s16
    s_addc_u32 s59, s73, 0
    s_add_u32 s24, s58, 4096
    s_addc_u32 s25, s59, 0
    s_add_u32 s26, s58, 12288
    s_addc_u32 s27, s59, 0
    s_add_u32 s28, s58, 20480
    s_addc_u32 s29, s59, 0
    s_add_u32 s30, s58, 28672
    s_addc_u32 s31, s59, 0
    s_add_u32 s44, s58, 36864
    s_addc_u32 s45, s59, 0
    s_add_u32 s52, s58, 45056
    s_addc_u32 s53, s59, 0
    s_add_u32 s54, s58, 53248
    s_addc_u32 s55, s59, 0
    s_add_u32 s20, s58, 61440
    s_addc_u32 s21, s59, 0
    s_lshl_b32 s58, s41, 2
    s_add_u32 s58, s58, s56
    s_mul_i32 s58, s58, 25
    v_min_u32 v15, 24, v0
    v_add_u32 v15, s58, v15
    v_lshlrev_b32 v15, 7, v15
    s_lshl_b32 s59, s48, 13
    s_add_u32 s59, s59, 122880
    s_add_u32 s58, s56, 1
    s_and_b32 s58, s58, 3
    s_lshl_b32 s58, s58, 11
    s_add_u32 s58, s58, s59
    v_add_u32 v240, s58, v1
    s_add_u32 s58, s56, 2
    s_and_b32 s58, s58, 3
    s_lshl_b32 s58, s58, 11
    s_add_u32 s58, s58, s59
    v_add_u32 v241, s58, v1
    s_add_u32 s58, s56, 3
    s_and_b32 s58, s58, 3
    s_lshl_b32 s58, s58, 11
    s_add_u32 s58, s58, s59
    v_add_u32 v242, s58, v1
    s_add_u32 s58, s56, 4
    s_and_b32 s58, s58, 3
    s_lshl_b32 s58, s58, 11
    s_add_u32 s58, s58, s59
    v_add_u32 v243, s58, v1
    v_mov_b32 v244, 163816
L_ph2:
    s_mov_b32 s63, 4194304
    s_mov_b64 exec, 0xffff
L_f1_spin:
    buffer_load_dwordx2 v[254:255], v4, s[32:35], 0 offen sc1
    s_sub_u32 s63, s63, 1
    s_cbranch_scc1 L_end
    s_waitcnt vmcnt(0)
    v_cmp_ne_u64 vcc, s[76:77], v[254:255]
    s_cbranch_vccnz L_f1_spin
    s_mov_b64 exec, -1
    global_load_dwordx4 v[176:179], v1, s[24:25] offset:-4096 sc1
    global_load_dwordx4 v[180:183], v1, s[24:25] offset:-3072 sc1
    s_mov_b32 s63, 4194304
L_q_spin:
    ds_read_b32 v253, v244 offset:0
    s_sub_u32 s63, s63, 1
    s_cbranch_scc1 L_end
    s_waitcnt lgkmcnt(0)
    v_readfirstlane_b32 s61, v253
    s_cmp_ge_u32 s61, 4
    s_cbranch_scc0 L_q_spin
    ds_read_b128 v[40:43], v243
    ds_read_b128 v[44:47], v243 offset:1024
    ds_read_b128 v[16:19], v240
    ds_read_b128 v[20:23], v240 offset:1024
    ds_read_b128 v[24:27], v241
    ds_read_b128 v[28:31], v241 offset:1024
    ds_read_b128 v[32:35], v242
    ds_read_b128 v[36:39], v242 offset:1024
    s_waitcnt vmcnt(0)
    s_waitcnt lgkmcnt(6)
    v_mfma_f32_32x32x16_bf16 v[112:127], v[176:179], v[40:43], 0
    v_mfma_f32_32x32x16_bf16 v[112:127], v[180:183], v[44:47], v[112:127]
    global_load_dwordx4 v[184:187], v1, s[24:25] offset:0 sc1
    global_load_dwordx4 v[188:191], v1, s[24:25] offset:1024 sc1
    global_load_dwordx4 v[208:211], v1, s[24:25] offset:-2048 sc1
    global_load_dwordx4 v[212:215], v1, s[24:25] offset:-1024 sc1
    s_waitcnt lgkmcnt(0)
    s_nop 6
    v_max3_f32 v240, v112, v113, v114
    v_max3_f32 v241, v115, v116, v117
    v_max3_f32 v240, v240, v118, v119
    v_max3_f32 v241, v241, v120, v121
    v_max3_f32 v240, v240, v122, v123
    v_max3_f32 v241, v241, v124, v125
    v_max3_f32 v240, v240, v126, v127
    v_max_f32 v240, v240, v241
    v_mov_b32 v241, v240
    s_nop 1
    v_permlane32_swap_b32 v240, v241
    v_max_f32 v240, v240, v241
    v_xor_b32 v240, 0x80000000, v240
    s_mov_b32 exec_lo, 0
    v_lshrrev_b32 v46, 16, v240
    s_mov_b32 exec_lo, -1
    ds_write_b32 v7, v46
    s_mov_b64 exec, 1
    ds_add_u32 v3, v5 offset:0
    s_mov_b64 exec, -1
    v_mfma_f32_32x32x16_bf16 v[112:127], v[176:179], v[40:43], 0
    v_mfma_f32_32x32x16_bf16 v[112:127], v[180:183], v[44:47], v[112:127]
    global_load_dwordx4 v[216:219], v1, s[24:25] offset:2048 sc1
    global_load_dwordx4 v[220:223], v1, s[24:25] offset:3072 sc1
    s_nop 9
    global_load_dwordx4 v[192:195], v1, s[26:27] offset:-4096 sc1
    v_exp_f32 v112, v112
    v_exp_f32 v113, v113
    v_exp_f32 v114, v114
    v_exp_f32 v115, v115
    s_waitcnt vmcnt(5)
    v_mfma_f32_32x32x16_bf16 v[128:143], v[184:187], v[40:43], 0
    global_load_dwordx4 v[196:199], v1, s[26:27] offset:-3072 sc1
    v_exp_f32 v116, v116
    v_exp_f32 v117, v117
    v_exp_f32 v118, v118
    v_exp_f32 v119, v119
    v_mfma_f32_32x32x16_bf16 v[128:143], v[188:191], v[44:47], v[128:143]
    v_exp_f32 v120, v120
    v_exp_f32 v121, v121
    v_exp_f32 v122, v122
    v_exp_f32 v123, v123
    s_mov_b32 s63, 4194304
    ds_read_b32 v253, v3
    v_exp_f32 v124, v124
    v_exp_f32 v125, v125
    v_exp_f32 v126, v126
    v_exp_f32 v127, v127
L_m_re:
    s_waitcnt lgkmcnt(0)
    v_readfirstlane_b32 s61, v253
    s_sub_u32 s63, s63, 1
    ds_read_b32 v253, v3
    s_cbranch_scc1 L_end
    s_cmp_ge_u32 s61, 4
    s_cbranch_scc0 L_m_re
L_m_back:
    ds_read_b32 v22, v8
    ds_read_b32 v30, v9
    ds_read_b32 v38, v10
    s_waitcnt vmcnt(4)
    v_smfmac_f32_32x32x32_bf16 v[96:111], v[208:211], v[112:119], v2
    global_load_dwordx4 v[224:227], v1, s[26:27] offset:-2048 sc1
    v_exp_f32 v128, v128
    v_exp_f32 v129, v129
    v_exp_f32 v130, v130
    v_exp_f32 v131, v131
    v_smfmac_f32_32x32x32_bf16 v[96:111], v[212:215], v[120:127], v2
    global_load_dwordx4 v[228:231], v1, s[26:27] offset:-1024 sc1
    v_exp_f32 v132, v132
    v_exp_f32 v133, v133
    v_exp_f32 v134, v134
    v_exp_f32 v135, v135
    v_mfma_f32_32x32x16_bf16 v[144:159], v[176:179], v[16:19], 0
    v_exp_f32 v136, v136
    v_exp_f32 v137, v137
    v_exp_f32 v138, v138
    v_exp_f32 v139, v139
    s_waitcnt lgkmcnt(0)
    v_mfma_f32_32x32x16_bf16 v[144:159], v[180:183], v[20:23], v[144:159]
    v_exp_f32 v140, v140
    v_exp_f32 v141, v141
    v_exp_f32 v142, v142
    v_exp_f32 v143, v143
    s_nop 6
    v_mfma_f32_32x32x16_bf16 v[112:127], v[176:179], v[24:27], 0
    global_load_dwordx4 v[200:203], v1, s[26:27] offset:0 sc1
    v_exp_f32 v144, v144
    v_exp_f32 v145, v145
    v_exp_f32 v146, v146
    v_exp_f32 v147, v147
    v_mfma_f32_32x32x16_bf16 v[112:127], v[180:183], v[28:31], v[112:127]
    global_load_dwordx4 v[204:207], v1, s[26:27] offset:1024 sc1
    v_exp_f32 v148, v148
    v_exp_f32 v149, v149
    v_exp_f32 v150, v150
    v_exp_f32 v151, v151
    s_waitcnt vmcnt(6)
    v_smfmac_f32_32x32x32_bf16 v[96:111], v[216:219], v[128:135], v2
    v_exp_f32 v152, v152
    v_exp_f32 v153, v153
    v_exp_f32 v154, v154
    v_exp_f32 v155, v155
    v_smfmac_f32_32x32x32_bf16 v[96:111], v[220:223], v[136:143], v2
    v_exp_f32 v156, v156
    v_exp_f32 v157, v157
    v_exp_f32 v158, v158
    v_exp_f32 v159, v159
    v_mfma_f32_32x32x16_bf16 v[128:143], v[176:179], v[32:35], 0
    global_load_dwordx4 v[232:235], v1, s[26:27] offset:2048 sc1
    v_exp_f32 v112, v112
    v_exp_f32 v113, v113
    v_exp_f32 v114, v114
    v_exp_f32 v115, v115
    v_mfma_f32_32x32x16_bf16 v[128:143], v[180:183], v[36:39], v[128:143]
    global_load_dwordx4 v[236:239], v1, s[26:27] offset:3072 sc1
    v_exp_f32 v116, v116
    v_exp_f32 v117, v117
    v_exp_f32 v118, v118
    v_exp_f32 v119, v119
    v_smfmac_f32_32x32x32_bf16 v[48:63], v[208:211], v[144:151], v2
    v_exp_f32 v120, v120
    v_exp_f32 v121, v121
    v_exp_f32 v122, v122
    v_exp_f32 v123, v123
    v_smfmac_f32_32x32x32_bf16 v[48:63], v[212:215], v[152:159], v2
    v_exp_f32 v124, v124
    v_exp_f32 v125, v125
    v_exp_f32 v126, v126
    v_exp_f32 v127, v127
    v_mfma_f32_32x32x16_bf16 v[144:159], v[184:187], v[16:19], 0
    global_load_dwordx4 v[176:179], v1, s[28:29] offset:-4096 sc1
    v_exp_f32 v128, v128
    v_exp_f32 v129, v129
    v_exp_f32 v130, v130
    v_exp_f32 v131, v131
    v_mfma_f32_32x32x16_bf16 v[144:159], v[188:191], v[20:23], v[144:159]
    global_load_dwordx4 v[180:183], v1, s[28:29] offset:-3072 sc1
    v_exp_f32 v132, v132
    v_exp_f32 v133, v133
    v_exp_f32 v134, v134
    v_exp_f32 v135, v135
    v_smfmac_f32_32x32x32_bf16 v[64:79], v[208:211], v[112:119], v2
    v_exp_f32 v136, v136
    v_exp_f32 v137, v137
    v_exp_f32 v138, v138
    v_exp_f32 v139, v139
    v_smfmac_f32_32x32x32_bf16 v[64:79], v[212:215], v[120:127], v2
    v_exp_f32 v140, v140
    v_exp_f32 v141, v141
    v_exp_f32 v142, v142
    v_exp_f32 v143, v143
    v_mfma_f32_32x32x16_bf16 v[112:127], v[184:187], v[24:27], 0
    v_exp_f32 v144, v144
    v_exp_f32 v145, v145
    v_exp_f32 v146, v146
    v_exp_f32 v147, v147
    v_mfma_f32_32x32x16_bf16 v[112:127], v[188:191], v[28:31], v[112:127]
    v_exp_f32 v148, v148
    v_exp_f32 v149, v149
    v_exp_f32 v150, v150
    v_exp_f32 v151, v151
    v_smfmac_f32_32x32x32_bf16 v[80:95], v[208:211], v[128:135], v2
    v_exp_f32 v152, v152
    v_exp_f32 v153, v153
    v_exp_f32 v154, v154
    v_exp_f32 v155, v155
    v_smfmac_f32_32x32x32_bf16 v[80:95], v[212:215], v[136:143], v2
    v_exp_f32 v156, v156
    v_exp_f32 v157, v157
    v_exp_f32 v158, v158
    v_exp_f32 v159, v159
    v_mfma_f32_32x32x16_bf16 v[128:143], v[184:187], v[32:35], 0
    global_load_dwordx4 v[208:211], v1, s[28:29] offset:-2048 sc1
    v_exp_f32 v112, v112
    v_exp_f32 v113, v113
    v_exp_f32 v114, v114
    v_exp_f32 v115, v115
    v_mfma_f32_32x32x16_bf16 v[128:143], v[188:191], v[36:39], v[128:143]
    global_load_dwordx4 v[212:215], v1, s[28:29] offset:-1024 sc1
    v_exp_f32 v116, v116
    v_exp_f32 v117, v117
    v_exp_f32 v118, v118
    v_exp_f32 v119, v119
    v_smfmac_f32_32x32x32_bf16 v[48:63], v[216:219], v[144:151], v2
    s_mov_b32 s63, 4194304
    ds_read_b32 v253, v165
    v_exp_f32 v120, v120
    v_exp_f32 v121, v121
    v_exp_f32 v122, v122
    v_exp_f32 v123, v123
    v_smfmac_f32_32x32x32_bf16 v[48:63], v[220:223], v[152:159], v2
    s_waitcnt vmcnt(8)
    v_exp_f32 v124, v124
    v_exp_f32 v125, v125
    v_exp_f32 v126, v126
    v_exp_f32 v127, v127
    v_mfma_f32_32x32x16_bf16 v[144:159], v[192:195], v[16:19], 0
    global_load_dwordx4 v[184:187], v1, s[28:29] offset:0 sc1
    v_exp_f32 v128, v128
    v_exp_f32 v129, v129
    v_exp_f32 v130, v130
    v_exp_f32 v131, v131
    v_mfma_f32_32x32x16_bf16 v[144:159], v[196:199], v[20:23], v[144:159]
    global_load_dwordx4 v[188:191], v1, s[28:29] offset:1024 sc1
    v_exp_f32 v132, v132
    v_exp_f32 v133, v133
    v_exp_f32 v134, v134
    v_exp_f32 v135, v135
    v_smfmac_f32_32x32x32_bf16 v[64:79], v[216:219], v[112:119], v2
L_c0_re:
    s_waitcnt lgkmcnt(0)
    v_readfirstlane_b32 s61, v253
    s_sub_u32 s63, s63, 1
    ds_read_b32 v253, v165
    s_cbranch_scc1 L_end
    s_cmp_ge_u32 s61, 4
    s_cbranch_scc0 L_c0_re
L_c0_back:
    v_exp_f32 v136, v136
    v_exp_f32 v137, v137
    v_exp_f32 v138, v138
    v_exp_f32 v139, v139
    v_smfmac_f32_32x32x32_bf16 v[64:79], v[220:223], v[120:127], v2
    v_exp_f32 v140, v140
    v_exp_f32 v141, v141
    v_exp_f32 v142, v142
    v_exp_f32 v143, v143
    v_mfma_f32_32x32x16_bf16 v[112:127], v[192:195], v[24:27], 0
    v_exp_f32 v144, v144
    v_exp_f32 v145, v145
    v_exp_f32 v146, v146
    v_exp_f32 v147, v147
    v_mfma_f32_32x32x16_bf16 v[112:127], v[196:199], v[28:31], v[112:127]
    v_exp_f32 v148, v148
    v_exp_f32 v149, v149
    v_exp_f32 v150, v150
    v_exp_f32 v151, v151
    v_smfmac_f32_32x32x32_bf16 v[80:95], v[216:219], v[128:135], v2
    v_exp_f32 v152, v152
    v_exp_f32 v153, v153
    v_exp_f32 v154, v154
    v_exp_f32 v155, v155
    v_smfmac_f32_32x32x32_bf16 v[80:95], v[220:223], v[136:143], v2
    v_exp_f32 v156, v156
    v_exp_f32 v157, v157
    v_exp_f32 v158, v158
    v_exp_f32 v159, v159
    v_mfma_f32_32x32x16_bf16 v[128:143], v[192:195], v[32:35], 0
    global_load_dwordx4 v[216:219], v1, s[28:29] offset:2048 sc1
    v_exp_f32 v112, v112
    v_exp_f32 v113, v113
    v_exp_f32 v114, v114
    v_exp_f32 v115, v115
    v_mfma_f32_32x32x16_bf16 v[128:143], v[196:199], v[36:39], v[128:143]
    global_load_dwordx4 v[220:223], v1, s[28:29] offset:3072 sc1
    v_exp_f32 v116, v116
    v_exp_f32 v117, v117
    v_exp_f32 v118, v118
    v_exp_f32 v119, v119
    v_smfmac_f32_32x32x32_bf16 v[48:63], v[224:227], v[144:151], v2
    v_exp_f32 v120, v120
    v_exp_f32 v121, v121
    v_exp_f32 v122, v122
    v_exp_f32 v123, v123
    v_smfmac_f32_32x32x32_bf16 v[48:63], v[228:231], v[152:159], v2
    v_exp_f32 v124, v124
    v_exp_f32 v125, v125
    v_exp_f32 v126, v126
    v_exp_f32 v127, v127
    v_mfma_f32_32x32x16_bf16 v[144:159], v[192:195], v[40:43], 0
    v_exp_f32 v128, v128
    v_exp_f32 v129, v129
    v_exp_f32 v130, v130
    v_exp_f32 v131, v131
    v_mfma_f32_32x32x16_bf16 v[144:159], v[196:199], v[44:47], v[144:159]
    v_exp_f32 v132, v132
    v_exp_f32 v133, v133
    v_exp_f32 v134, v134
    v_exp_f32 v135, v135
    v_smfmac_f32_32x32x32_bf16 v[64:79], v[224:227], v[112:119], v2
    v_exp_f32 v136, v136
    v_exp_f32 v137, v137
    v_exp_f32 v138, v138
    v_exp_f32 v139, v139
    v_smfmac_f32_32x32x32_bf16 v[64:79], v[228:231], v[120:127], v2
    s_waitcnt vmcnt(8)
    v_exp_f32 v140, v140
    v_exp_f32 v141, v141
    v_exp_f32 v142, v142
    v_exp_f32 v143, v143
    v_mfma_f32_32x32x16_bf16 v[112:127], v[200:203], v[16:19], 0
    global_load_dwordx4 v[192:195], v1, s[30:31] offset:-4096 sc1
    v_exp_f32 v144, v144
    v_exp_f32 v145, v145
    v_exp_f32 v146, v146
    v_exp_f32 v147, v147
    v_mfma_f32_32x32x16_bf16 v[112:127], v[204:207], v[20:23], v[112:127]
    global_load_dwordx4 v[196:199], v1, s[30:31] offset:-3072 sc1
    v_exp_f32 v148, v148
    v_exp_f32 v149, v149
    v_exp_f32 v150, v150
    v_exp_f32 v151, v151
    v_smfmac_f32_32x32x32_bf16 v[80:95], v[224:227], v[128:135], v2
    v_exp_f32 v152, v152
    v_exp_f32 v153, v153
    v_exp_f32 v154, v154
    v_exp_f32 v155, v155
    v_smfmac_f32_32x32x32_bf16 v[80:95], v[228:231], v[136:143], v2
    v_exp_f32 v156, v156
    v_exp_f32 v157, v157
    v_exp_f32 v158, v158
    v_exp_f32 v159, v159
    v_mfma_f32_32x32x16_bf16 v[128:143], v[200:203], v[24:27], 0
    v_exp_f32 v112, v112
    v_exp_f32 v113, v113
    v_exp_f32 v114, v114
    v_exp_f32 v115, v115
    v_mfma_f32_32x32x16_bf16 v[128:143], v[204:207], v[28:31], v[128:143]
    v_exp_f32 v116, v116
    v_exp_f32 v117, v117
    v_exp_f32 v118, v118
    v_exp_f32 v119, v119
    v_smfmac_f32_32x32x32_bf16 v[96:111], v[224:227], v[144:151], v2
    v_exp_f32 v120, v120
    v_exp_f32 v121, v121
    v_exp_f32 v122, v122
    v_exp_f32 v123, v123
    v_smfmac_f32_32x32x32_bf16 v[96:111], v[228:231], v[152:159], v2
    v_exp_f32 v124, v124
    v_exp_f32 v125, v125
    v_exp_f32 v126, v126
    v_exp_f32 v127, v127
    v_mfma_f32_32x32x16_bf16 v[144:159], v[200:203], v[32:35], 0
    global_load_dwordx4 v[224:227], v1, s[30:31] offset:-2048 sc1
    v_exp_f32 v128, v128
    v_exp_f32 v129, v129
    v_exp_f32 v130, v130
    v_exp_f32 v131, v131
    v_mfma_f32_32x32x16_bf16 v[144:159], v[204:207], v[36:39], v[144:159]
    v_exp_f32 v132, v132
    v_exp_f32 v133, v133
    v_exp_f32 v134, v134
    v_exp_f32 v135, v135
    v_smfmac_f32_32x32x32_bf16 v[48:63], v[232:235], v[112:119], v2
    v_exp_f32 v136, v136
    v_exp_f32 v137, v137
    v_exp_f32 v138, v138
    v_exp_f32 v139, v139
    v_smfmac_f32_32x32x32_bf16 v[48:63], v[236:239], v[120:127], v2
    v_exp_f32 v140, v140
    v_exp_f32 v141, v141
    v_exp_f32 v142, v142
    v_exp_f32 v143, v143
    v_mfma_f32_32x32x16_bf16 v[112:127], v[200:203], v[40:43], 0
    global_load_dwordx4 v[228:231], v1, s[30:31] offset:-1024 sc1
    v_exp_f32 v144, v144
    v_exp_f32 v145, v145
    v_exp_f32 v146, v146
    v_exp_f32 v147, v147
    v_mfma_f32_32x32x16_bf16 v[112:127], v[204:207], v[44:47], v[112:127]
    v_exp_f32 v148, v148
    v_exp_f32 v149, v149
    v_exp_f32 v150, v150
    v_exp_f32 v151, v151
    v_smfmac_f32_32x32x32_bf16 v[64:79], v[232:235], v[128:135], v2
    v_exp_f32 v152, v152
    v_exp_f32 v153, v153
    v_exp_f32 v154, v154
    v_exp_f32 v155, v155
    v_smfmac_f32_32x32x32_bf16 v[64:79], v[236:239], v[136:143], v2
    s_waitcnt vmcnt(8)
    v_exp_f32 v156, v156
    v_exp_f32 v157, v157
    v_exp_f32 v158, v158
    v_exp_f32 v159, v159
    v_mfma_f32_32x32x16_bf16 v[128:143], v[176:179], v[16:19], 0
    global_load_dwordx4 v[200:203], v1, s[30:31] offset:0 sc1
    v_exp_f32 v112, v112
    v_exp_f32 v113, v113
    v_exp_f32 v114, v114
    v_exp_f32 v115, v115
    v_mfma_f32_32x32x16_bf16 v[128:143], v[180:183], v[20:23], v[128:143]
    v_exp_f32 v116, v116
    v_exp_f32 v117, v117
    v_exp_f32 v118, v118
    v_exp_f32 v119, v119
    v_smfmac_f32_32x32x32_bf16 v[80:95], v[232:235], v[144:151], v2
    v_exp_f32 v120, v120
    v_exp_f32 v121, v121
    v_exp_f32 v122, v122
    v_exp_f32 v123, v123
    v_smfmac_f32_32x32x32_bf16 v[80:95], v[236:239], v[152:159], v2
    v_exp_f32 v124, v124
    v_exp_f32 v125, v125
    v_exp_f32 v126, v126
    v_exp_f32 v127, v127
    v_mfma_f32_32x32x16_bf16 v[144:159], v[176:179], v[24:27], 0
    global_load_dwordx4 v[204:207], v1, s[30:31] offset:1024 sc1
    v_exp_f32 v128, v128
    v_exp_f32 v129, v129
    v_exp_f32 v130, v130
    v_exp_f32 v131, v131
    v_mfma_f32_32x32x16_bf16 v[144:159], v[180:183], v[28:31], v[144:159]
    v_exp_f32 v132, v132
    v_exp_f32 v133, v133
    v_exp_f32 v134, v134
    v_exp_f32 v135, v135
    v_smfmac_f32_32x32x32_bf16 v[96:111], v[232:235], v[112:119], v2
    v_exp_f32 v136, v136
    v_exp_f32 v137, v137
    v_exp_f32 v138, v138
    v_exp_f32 v139, v139
    v_smfmac_f32_32x32x32_bf16 v[96:111], v[236:239], v[120:127], v2
    v_exp_f32 v140, v140
    v_exp_f32 v141, v141
    v_exp_f32 v142, v142
    v_exp_f32 v143, v143
    v_mfma_f32_32x32x16_bf16 v[112:127], v[176:179], v[32:35], 0
    global_load_dwordx4 v[232:235], v1, s[30:31] offset:2048 sc1
    v_exp_f32 v144, v144
    v_exp_f32 v145, v145
    v_exp_f32 v146, v146
    v_exp_f32 v147, v147
    v_mfma_f32_32x32x16_bf16 v[112:127], v[180:183], v[36:39], v[112:127]
    v_exp_f32 v148, v148
    v_exp_f32 v149, v149
    v_exp_f32 v150, v150
    v_exp_f32 v151, v151
    v_smfmac_f32_32x32x32_bf16 v[48:63], v[208:211], v[128:135], v2
    v_exp_f32 v152, v152
    v_exp_f32 v153, v153
    v_exp_f32 v154, v154
    v_exp_f32 v155, v155
    v_smfmac_f32_32x32x32_bf16 v[48:63], v[212:215], v[136:143], v2
    v_exp_f32 v156, v156
    v_exp_f32 v157, v157
    v_exp_f32 v158, v158
    v_exp_f32 v159, v159
    v_mfma_f32_32x32x16_bf16 v[128:143], v[176:179], v[40:43], 0
    global_load_dwordx4 v[236:239], v1, s[30:31] offset:3072 sc1
    v_exp_f32 v112, v112
    v_exp_f32 v113, v113
    v_exp_f32 v114, v114
    v_exp_f32 v115, v115
    v_mfma_f32_32x32x16_bf16 v[128:143], v[180:183], v[44:47], v[128:143]
    v_exp_f32 v116, v116
    v_exp_f32 v117, v117
    v_exp_f32 v118, v118
    v_exp_f32 v119, v119
    v_smfmac_f32_32x32x32_bf16 v[64:79], v[208:211], v[144:151], v2
    v_exp_f32 v120, v120
    v_exp_f32 v121, v121
    v_exp_f32 v122, v122
    v_exp_f32 v123, v123
    v_smfmac_f32_32x32x32_bf16 v[64:79], v[212:215], v[152:159], v2
    s_waitcnt vmcnt(8)
    v_exp_f32 v124, v124
    v_exp_f32 v125, v125
    v_exp_f32 v126, v126
    v_exp_f32 v127, v127
    v_mfma_f32_32x32x16_bf16 v[144:159], v[184:187], v[16:19], 0
    global_load_dwordx4 v[176:179], v1, s[44:45] offset:-4096 sc1
    v_exp_f32 v128, v128
    v_exp_f32 v129, v129
    v_exp_f32 v130, v130
    v_exp_f32 v131, v131
    v_mfma_f32_32x32x16_bf16 v[144:159], v[188:191], v[20:23], v[144:159]
    v_exp_f32 v132, v132
    v_exp_f32 v133, v133
    v_exp_f32 v134, v134
    v_exp_f32 v135, v135
    v_smfmac_f32_32x32x32_bf16 v[80:95], v[208:211], v[112:119], v2
    v_exp_f32 v136, v136
    v_exp_f32 v137, v137
    v_exp_f32 v138, v138
    v_exp_f32 v139, v139
    v_smfmac_f32_32x32x32_bf16 v[80:95], v[212:215], v[120:127], v2
    v_exp_f32 v140, v140
    v_exp_f32 v141, v141
    v_exp_f32 v142, v142
    v_exp_f32 v143, v143
    v_mfma_f32_32x32x16_bf16 v[112:127], v[184:187], v[24:27], 0
    global_load_dwordx4 v[180:183], v1, s[44:45] offset:-3072 sc1
    v_exp_f32 v144, v144
    v_exp_f32 v145, v145
    v_exp_f32 v146, v146
    v_exp_f32 v147, v147
    v_mfma_f32_32x32x16_bf16 v[112:127], v[188:191], v[28:31], v[112:127]
    v_exp_f32 v148, v148
    v_exp_f32 v149, v149
    v_exp_f32 v150, v150
    v_exp_f32 v151, v151
    v_smfmac_f32_32x32x32_bf16 v[96:111], v[208:211], v[128:135], v2
    v_exp_f32 v152, v152
    v_exp_f32 v153, v153
    v_exp_f32 v154, v154
    v_exp_f32 v155, v155
    v_smfmac_f32_32x32x32_bf16 v[96:111], v[212:215], v[136:143], v2
    v_exp_f32 v156, v156
    v_exp_f32 v157, v157
    v_exp_f32 v158, v158
    v_exp_f32 v159, v159
    v_mfma_f32_32x32x16_bf16 v[128:143], v[184:187], v[32:35], 0
    global_load_dwordx4 v[208:211], v1, s[44:45] offset:-2048 sc1
    v_exp_f32 v112, v112
    v_exp_f32 v113, v113
    v_exp_f32 v114, v114
    v_exp_f32 v115, v115
    v_mfma_f32_32x32x16_bf16 v[128:143], v[188:191], v[36:39], v[128:143]
    v_exp_f32 v116, v116
    v_exp_f32 v117, v117
    v_exp_f32 v118, v118
    v_exp_f32 v119, v119
    v_smfmac_f32_32x32x32_bf16 v[48:63], v[216:219], v[144:151], v2
    v_exp_f32 v120, v120
    v_exp_f32 v121, v121
    v_exp_f32 v122, v122
    v_exp_f32 v123, v123
    v_smfmac_f32_32x32x32_bf16 v[48:63], v[220:223], v[152:159], v2
    v_exp_f32 v124, v124
    v_exp_f32 v125, v125
    v_exp_f32 v126, v126
    v_exp_f32 v127, v127
    v_mfma_f32_32x32x16_bf16 v[144:159], v[184:187], v[40:43], 0
    global_load_dwordx4 v[212:215], v1, s[44:45] offset:-1024 sc1
    v_exp_f32 v128, v128
    v_exp_f32 v129, v129
    v_exp_f32 v130, v130
    v_exp_f32 v131, v131
    v_mfma_f32_32x32x16_bf16 v[144:159], v[188:191], v[44:47], v[144:159]
    v_exp_f32 v132, v132
    v_exp_f32 v133, v133
    v_exp_f32 v134, v134
    v_exp_f32 v135, v135
    v_smfmac_f32_32x32x32_bf16 v[64:79], v[216:219], v[112:119], v2
    v_exp_f32 v136, v136
    v_exp_f32 v137, v137
    v_exp_f32 v138, v138
    v_exp_f32 v139, v139
    v_smfmac_f32_32x32x32_bf16 v[64:79], v[220:223], v[120:127], v2
    s_waitcnt vmcnt(8)
    v_exp_f32 v140, v140
    v_exp_f32 v141, v141
    v_exp_f32 v142, v142
    v_exp_f32 v143, v143
    v_mfma_f32_32x32x16_bf16 v[112:127], v[192:195], v[16:19], 0
    global_load_dwordx4 v[184:187], v1, s[44:45] offset:0 sc1
    v_exp_f32 v144, v144
    v_exp_f32 v145, v145
    v_exp_f32 v146, v146
    v_exp_f32 v147, v147
    v_mfma_f32_32x32x16_bf16 v[112:127], v[196:199], v[20:23], v[112:127]
    v_exp_f32 v148, v148
    v_exp_f32 v149, v149
    v_exp_f32 v150, v150
    v_exp_f32 v151, v151
    v_smfmac_f32_32x32x32_bf16 v[80:95], v[216:219], v[128:135], v2
    v_exp_f32 v152, v152
    v_exp_f32 v153, v153
    v_exp_f32 v154, v154
    v_exp_f32 v155, v155
    v_smfmac_f32_32x32x32_bf16 v[80:95], v[220:223], v[136:143], v2
    v_exp_f32 v156, v156
    v_exp_f32 v157, v157
    v_exp_f32 v158, v158
    v_exp_f32 v159, v159
    v_mfma_f32_32x32x16_bf16 v[128:143], v[192:195], v[24:27], 0
    global_load_dwordx4 v[188:191], v1, s[44:45] offset:1024 sc1
    v_exp_f32 v112, v112
    v_exp_f32 v113, v113
    v_exp_f32 v114, v114
    v_exp_f32 v115, v115
    v_mfma_f32_32x32x16_bf16 v[128:143], v[196:199], v[28:31], v[128:143]
    v_exp_f32 v116, v116
    v_exp_f32 v117, v117
    v_exp_f32 v118, v118
    v_exp_f32 v119, v119
    v_smfmac_f32_32x32x32_bf16 v[96:111], v[216:219], v[144:151], v2
    v_exp_f32 v120, v120
    v_exp_f32 v121, v121
    v_exp_f32 v122, v122
    v_exp_f32 v123, v123
    v_smfmac_f32_32x32x32_bf16 v[96:111], v[220:223], v[152:159], v2
    v_exp_f32 v124, v124
    v_exp_f32 v125, v125
    v_exp_f32 v126, v126
    v_exp_f32 v127, v127
    v_mfma_f32_32x32x16_bf16 v[144:159], v[192:195], v[32:35], 0
    global_load_dwordx4 v[216:219], v1, s[44:45] offset:2048 sc1
    v_exp_f32 v128, v128
    v_exp_f32 v129, v129
    v_exp_f32 v130, v130
    v_exp_f32 v131, v131
    v_mfma_f32_32x32x16_bf16 v[144:159], v[196:199], v[36:39], v[144:159]
    v_exp_f32 v132, v132
    v_exp_f32 v133, v133
    v_exp_f32 v134, v134
    v_exp_f32 v135, v135
    v_smfmac_f32_32x32x32_bf16 v[48:63], v[224:227], v[112:119], v2
    v_exp_f32 v136, v136
    v_exp_f32 v137, v137
    v_exp_f32 v138, v138
    v_exp_f32 v139, v139
    v_smfmac_f32_32x32x32_bf16 v[48:63], v[228:231], v[120:127], v2
    v_exp_f32 v140, v140
    v_exp_f32 v141, v141
    v_exp_f32 v142, v142
    v_exp_f32 v143, v143
    v_mfma_f32_32x32x16_bf16 v[112:127], v[192:195], v[40:43], 0
    global_load_dwordx4 v[220:223], v1, s[44:45] offset:3072 sc1
    v_exp_f32 v144, v144
    v_exp_f32 v145, v145
    v_exp_f32 v146, v146
    v_exp_f32 v147, v147
    v_mfma_f32_32x32x16_bf16 v[112:127], v[196:199], v[44:47], v[112:127]
    v_exp_f32 v148, v148
    v_exp_f32 v149, v149
    v_exp_f32 v150, v150
    v_exp_f32 v151, v151
    v_smfmac_f32_32x32x32_bf16 v[64:79], v[224:227], v[128:135], v2
    v_exp_f32 v152, v152
    v_exp_f32 v153, v153
    v_exp_f32 v154, v154
    v_exp_f32 v155, v155
    v_smfmac_f32_32x32x32_bf16 v[64:79], v[228:231], v[136:143], v2
    s_waitcnt vmcnt(8)
    v_exp_f32 v156, v156
    v_exp_f32 v157, v157
    v_exp_f32 v158, v158
    v_exp_f32 v159, v159
    v_mfma_f32_32x32x16_bf16 v[128:143], v[200:203], v[16:19], 0
    global_load_dwordx4 v[192:195], v1, s[52:53] offset:-4096 sc1
    v_exp_f32 v112, v112
    v_exp_f32 v113, v113
    v_exp_f32 v114, v114
    v_exp_f32 v115, v115
    v_mfma_f32_32x32x16_bf16 v[128:143], v[204:207], v[20:23], v[128:143]
    v_exp_f32 v116, v116
    v_exp_f32 v117, v117
    v_exp_f32 v118, v118
    v_exp_f32 v119, v119
    v_smfmac_f32_32x32x32_bf16 v[80:95], v[224:227], v[144:151], v2
    v_exp_f32 v120, v120
    v_exp_f32 v121, v121
    v_exp_f32 v122, v122
    v_exp_f32 v123, v123
    v_smfmac_f32_32x32x32_bf16 v[80:95], v[228:231], v[152:159], v2
    v_exp_f32 v124, v124
    v_exp_f32 v125, v125
    v_exp_f32 v126, v126
    v_exp_f32 v127, v127
    v_mfma_f32_32x32x16_bf16 v[144:159], v[200:203], v[24:27], 0
    global_load_dwordx4 v[196:199], v1, s[52:53] offset:-3072 sc1
    v_exp_f32 v128, v128
    v_exp_f32 v129, v129
    v_exp_f32 v130, v130
    v_exp_f32 v131, v131
    v_mfma_f32_32x32x16_bf16 v[144:159], v[204:207], v[28:31], v[144:159]
    v_exp_f32 v132, v132
    v_exp_f32 v133, v133
    v_exp_f32 v134, v134
    v_exp_f32 v135, v135
    v_smfmac_f32_32x32x32_bf16 v[96:111], v[224:227], v[112:119], v2
    v_exp_f32 v136, v136
    v_exp_f32 v137, v137
    v_exp_f32 v138, v138
    v_exp_f32 v139, v139
    v_smfmac_f32_32x32x32_bf16 v[96:111], v[228:231], v[120:127], v2
    v_exp_f32 v140, v140
    v_exp_f32 v141, v141
    v_exp_f32 v142, v142
    v_exp_f32 v143, v143
    v_mfma_f32_32x32x16_bf16 v[112:127], v[200:203], v[32:35], 0
    global_load_dwordx4 v[224:227], v1, s[52:53] offset:-2048 sc1
    v_exp_f32 v144, v144
    v_exp_f32 v145, v145
    v_exp_f32 v146, v146
    v_exp_f32 v147, v147
    v_mfma_f32_32x32x16_bf16 v[112:127], v[204:207], v[36:39], v[112:127]
    v_exp_f32 v148, v148
    v_exp_f32 v149, v149
    v_exp_f32 v150, v150
    v_exp_f32 v151, v151
    v_smfmac_f32_32x32x32_bf16 v[48:63], v[232:235], v[128:135], v2
    v_exp_f32 v152, v152
    v_exp_f32 v153, v153
    v_exp_f32 v154, v154
    v_exp_f32 v155, v155
    v_smfmac_f32_32x32x32_bf16 v[48:63], v[236:239], v[136:143], v2
    v_exp_f32 v156, v156
    v_exp_f32 v157, v157
    v_exp_f32 v158, v158
    v_exp_f32 v159, v159
    v_mfma_f32_32x32x16_bf16 v[128:143], v[200:203], v[40:43], 0
    global_load_dwordx4 v[228:231], v1, s[52:53] offset:-1024 sc1
    v_exp_f32 v112, v112
    v_exp_f32 v113, v113
    v_exp_f32 v114, v114
    v_exp_f32 v115, v115
    v_mfma_f32_32x32x16_bf16 v[128:143], v[204:207], v[44:47], v[128:143]
    v_exp_f32 v116, v116
    v_exp_f32 v117, v117
    v_exp_f32 v118, v118
    v_exp_f32 v119, v119
    v_smfmac_f32_32x32x32_bf16 v[64:79], v[232:235], v[144:151], v2
    buffer_load_dword v248, v15, s[36:39], 0 offen
    v_exp_f32 v120, v120
    v_exp_f32 v121, v121
    v_exp_f32 v122, v122
    v_exp_f32 v123, v123
    v_smfmac_f32_32x32x32_bf16 v[64:79], v[236:239], v[152:159], v2
    s_waitcnt vmcnt(9)
    v_exp_f32 v124, v124
    v_exp_f32 v125, v125
    v_exp_f32 v126, v126
    v_exp_f32 v127, v127
    v_mfma_f32_32x32x16_bf16 v[144:159], v[176:179], v[16:19], 0
    global_load_dwordx4 v[200:203], v1, s[52:53] offset:0 sc1
    v_exp_f32 v128, v128
    v_exp_f32 v129, v129
    v_exp_f32 v130, v130
    v_exp_f32 v131, v131
    v_mfma_f32_32x32x16_bf16 v[144:159], v[180:183], v[20:23], v[144:159]
    v_exp_f32 v132, v132
    v_exp_f32 v133, v133
    v_exp_f32 v134, v134
    v_exp_f32 v135, v135
    v_smfmac_f32_32x32x32_bf16 v[80:95], v[232:235], v[112:119], v2
    v_exp_f32 v136, v136
    v_exp_f32 v137, v137
    v_exp_f32 v138, v138
    v_exp_f32 v139, v139
    v_smfmac_f32_32x32x32_bf16 v[80:95], v[236:239], v[120:127], v2
    v_exp_f32 v140, v140
    v_exp_f32 v141, v141
    v_exp_f32 v142, v142
    v_exp_f32 v143, v143
    v_mfma_f32_32x32x16_bf16 v[112:127], v[176:179], v[24:27], 0
    global_load_dwordx4 v[204:207], v1, s[52:53] offset:1024 sc1
    v_exp_f32 v144, v144
    v_exp_f32 v145, v145
    v_exp_f32 v146, v146
    v_exp_f32 v147, v147
    v_mfma_f32_32x32x16_bf16 v[112:127], v[180:183], v[28:31], v[112:127]
    v_exp_f32 v148, v148
    v_exp_f32 v149, v149
    v_exp_f32 v150, v150
    v_exp_f32 v151, v151
    v_smfmac_f32_32x32x32_bf16 v[96:111], v[232:235], v[128:135], v2
    v_exp_f32 v152, v152
    v_exp_f32 v153, v153
    v_exp_f32 v154, v154
    v_exp_f32 v155, v155
    v_smfmac_f32_32x32x32_bf16 v[96:111], v[236:239], v[136:143], v2
    v_exp_f32 v156, v156
    v_exp_f32 v157, v157
    v_exp_f32 v158, v158
    v_exp_f32 v159, v159
    v_mfma_f32_32x32x16_bf16 v[128:143], v[176:179], v[32:35], 0
    global_load_dwordx4 v[232:235], v1, s[52:53] offset:2048 sc1
    v_exp_f32 v112, v112
    v_exp_f32 v113, v113
    v_exp_f32 v114, v114
    v_exp_f32 v115, v115
    v_mfma_f32_32x32x16_bf16 v[128:143], v[180:183], v[36:39], v[128:143]
    v_exp_f32 v116, v116
    v_exp_f32 v117, v117
    v_exp_f32 v118, v118
    v_exp_f32 v119, v119
    v_smfmac_f32_32x32x32_bf16 v[48:63], v[208:211], v[144:151], v2
    v_exp_f32 v120, v120
    v_exp_f32 v121, v121
    v_exp_f32 v122, v122
    v_exp_f32 v123, v123
    v_smfmac_f32_32x32x32_bf16 v[48:63], v[212:215], v[152:159], v2
    v_exp_f32 v124, v124
    v_exp_f32 v125, v125
    v_exp_f32 v126, v126
    v_exp_f32 v127, v127
    v_mfma_f32_32x32x16_bf16 v[144:159], v[176:179], v[40:43], 0
    global_load_dwordx4 v[236:239], v1, s[52:53] offset:3072 sc1
    v_exp_f32 v128, v128
    v_exp_f32 v129, v129
    v_exp_f32 v130, v130
    v_exp_f32 v131, v131
    v_mfma_f32_32x32x16_bf16 v[144:159], v[180:183], v[44:47], v[144:159]
    v_exp_f32 v132, v132
    v_exp_f32 v133, v133
    v_exp_f32 v134, v134
    v_exp_f32 v135, v135
    v_smfmac_f32_32x32x32_bf16 v[64:79], v[208:211], v[112:119], v2
    v_exp_f32 v136, v136
    v_exp_f32 v137, v137
    v_exp_f32 v138, v138
    v_exp_f32 v139, v139
    v_smfmac_f32_32x32x32_bf16 v[64:79], v[212:215], v[120:127], v2
    s_waitcnt vmcnt(9)
    v_exp_f32 v140, v140
    v_exp_f32 v141, v141
    v_exp_f32 v142, v142
    v_exp_f32 v143, v143
    v_mfma_f32_32x32x16_bf16 v[112:127], v[184:187], v[16:19], 0
    global_load_dwordx4 v[176:179], v1, s[54:55] offset:-4096 sc1
    v_exp_f32 v144, v144
    v_exp_f32 v145, v145
    v_exp_f32 v146, v146
    v_exp_f32 v147, v147
    v_mfma_f32_32x32x16_bf16 v[112:127], v[188:191], v[20:23], v[112:127]
    v_exp_f32 v148, v148
    v_exp_f32 v149, v149
    v_exp_f32 v150, v150
    v_exp_f32 v151, v151
    v_smfmac_f32_32x32x32_bf16 v[80:95], v[208:211], v[128:135], v2
    v_exp_f32 v152, v152
    v_exp_f32 v153, v153
    v_exp_f32 v154, v154
    v_exp_f32 v155, v155
    v_smfmac_f32_32x32x32_bf16 v[80:95], v[212:215], v[136:143], v2
    v_exp_f32 v156, v156
    v_exp_f32 v157, v157
    v_exp_f32 v158, v158
    v_exp_f32 v159, v159
    v_mfma_f32_32x32x16_bf16 v[128:143], v[184:187], v[24:27], 0
    global_load_dwordx4 v[180:183], v1, s[54:55] offset:-3072 sc1
    v_exp_f32 v112, v112
    v_exp_f32 v113, v113
    v_exp_f32 v114, v114
    v_exp_f32 v115, v115
    v_mfma_f32_32x32x16_bf16 v[128:143], v[188:191], v[28:31], v[128:143]
    v_exp_f32 v116, v116
    v_exp_f32 v117, v117
    v_exp_f32 v118, v118
    v_exp_f32 v119, v119
    v_smfmac_f32_32x32x32_bf16 v[96:111], v[208:211], v[144:151], v2
    v_exp_f32 v120, v120
    v_exp_f32 v121, v121
    v_exp_f32 v122, v122
    v_exp_f32 v123, v123
    v_smfmac_f32_32x32x32_bf16 v[96:111], v[212:215], v[152:159], v2
    v_exp_f32 v124, v124
    v_exp_f32 v125, v125
    v_exp_f32 v126, v126
    v_exp_f32 v127, v127
    v_mfma_f32_32x32x16_bf16 v[144:159], v[184:187], v[32:35], 0
    global_load_dwordx4 v[208:211], v1, s[54:55] offset:-2048 sc1
    v_exp_f32 v128, v128
    v_exp_f32 v129, v129
    v_exp_f32 v130, v130
    v_exp_f32 v131, v131
    v_mfma_f32_32x32x16_bf16 v[144:159], v[188:191], v[36:39], v[144:159]
    v_exp_f32 v132, v132
    v_exp_f32 v133, v133
    v_exp_f32 v134, v134
    v_exp_f32 v135, v135
    v_smfmac_f32_32x32x32_bf16 v[48:63], v[216:219], v[112:119], v2
    v_exp_f32 v136, v136
    v_exp_f32 v137, v137
    v_exp_f32 v138, v138
    v_exp_f32 v139, v139
    v_smfmac_f32_32x32x32_bf16 v[48:63], v[220:223], v[120:127], v2
    v_exp_f32 v140, v140
    v_exp_f32 v141, v141
    v_exp_f32 v142, v142
    v_exp_f32 v143, v143
    v_mfma_f32_32x32x16_bf16 v[112:127], v[184:187], v[40:43], 0
    global_load_dwordx4 v[212:215], v1, s[54:55] offset:-1024 sc1
    v_exp_f32 v144, v144
    v_exp_f32 v145, v145
    v_exp_f32 v146, v146
    v_exp_f32 v147, v147
    v_mfma_f32_32x32x16_bf16 v[112:127], v[188:191], v[44:47], v[112:127]
    v_exp_f32 v148, v148
    v_exp_f32 v149, v149
    v_exp_f32 v150, v150
    v_exp_f32 v151, v151
    v_smfmac_f32_32x32x32_bf16 v[64:79], v[216:219], v[128:135], v2
    v_exp_f32 v152, v152
    v_exp_f32 v153, v153
    v_exp_f32 v154, v154
    v_exp_f32 v155, v155
    v_smfmac_f32_32x32x32_bf16 v[64:79], v[220:223], v[136:143], v2
    s_waitcnt vmcnt(9)
    v_exp_f32 v156, v156
    v_exp_f32 v157, v157
    v_exp_f32 v158, v158
    v_exp_f32 v159, v159
    v_mfma_f32_32x32x16_bf16 v[128:143], v[192:195], v[16:19], 0
    global_load_dwordx4 v[184:187], v1, s[54:55] offset:0 sc1
    v_exp_f32 v112, v112
    v_exp_f32 v113, v113
    v_exp_f32 v114, v114
    v_exp_f32 v115, v115
    v_mfma_f32_32x32x16_bf16 v[128:143], v[196:199], v[20:23], v[128:143]
    v_exp_f32 v116, v116
    v_exp_f32 v117, v117
    v_exp_f32 v118, v118
    v_exp_f32 v119, v119
    v_smfmac_f32_32x32x32_bf16 v[80:95], v[216:219], v[144:151], v2
    v_exp_f32 v120, v120
    v_exp_f32 v121, v121
    v_exp_f32 v122, v122
    v_exp_f32 v123, v123
    v_smfmac_f32_32x32x32_bf16 v[80:95], v[220:223], v[152:159], v2
    v_exp_f32 v124, v124
    v_exp_f32 v125, v125
    v_exp_f32 v126, v126
    v_exp_f32 v127, v127
    v_mfma_f32_32x32x16_bf16 v[144:159], v[192:195], v[24:27], 0
    global_load_dwordx4 v[188:191], v1, s[54:55] offset:1024 sc1
    v_exp_f32 v128, v128
    v_exp_f32 v129, v129
    v_exp_f32 v130, v130
    v_exp_f32 v131, v131
    v_mfma_f32_32x32x16_bf16 v[144:159], v[196:199], v[28:31], v[144:159]
    v_exp_f32 v132, v132
    v_exp_f32 v133, v133
    v_exp_f32 v134, v134
    v_exp_f32 v135, v135
    v_smfmac_f32_32x32x32_bf16 v[96:111], v[216:219], v[112:119], v2
    v_exp_f32 v136, v136
    v_exp_f32 v137, v137
    v_exp_f32 v138, v138
    v_exp_f32 v139, v139
    v_smfmac_f32_32x32x32_bf16 v[96:111], v[220:223], v[120:127], v2
    v_exp_f32 v140, v140
    v_exp_f32 v141, v141
    v_exp_f32 v142, v142
    v_exp_f32 v143, v143
    v_mfma_f32_32x32x16_bf16 v[112:127], v[192:195], v[32:35], 0
    global_load_dwordx4 v[216:219], v1, s[54:55] offset:2048 sc1
    v_exp_f32 v144, v144
    v_exp_f32 v145, v145
    v_exp_f32 v146, v146
    v_exp_f32 v147, v147
    v_mfma_f32_32x32x16_bf16 v[112:127], v[196:199], v[36:39], v[112:127]
    global_load_dwordx4 v[220:223], v1, s[54:55] offset:3072 sc1
    v_exp_f32 v148, v148
    v_exp_f32 v149, v149
    v_exp_f32 v150, v150
    v_exp_f32 v151, v151
    v_smfmac_f32_32x32x32_bf16 v[48:63], v[224:227], v[128:135], v2
    v_exp_f32 v152, v152
    v_exp_f32 v153, v153
    v_exp_f32 v154, v154
    v_exp_f32 v155, v155
    v_smfmac_f32_32x32x32_bf16 v[48:63], v[228:231], v[136:143], v2
    v_exp_f32 v156, v156
    v_exp_f32 v157, v157
    v_exp_f32 v158, v158
    v_exp_f32 v159, v159
    v_mfma_f32_32x32x16_bf16 v[128:143], v[192:195], v[40:43], 0
    v_exp_f32 v112, v112
    v_exp_f32 v113, v113
    v_exp_f32 v114, v114
    v_exp_f32 v115, v115
    v_mfma_f32_32x32x16_bf16 v[128:143], v[196:199], v[44:47], v[128:143]
    v_exp_f32 v116, v116
    v_exp_f32 v117, v117
    v_exp_f32 v118, v118
    v_exp_f32 v119, v119
    v_smfmac_f32_32x32x32_bf16 v[64:79], v[224:227], v[144:151], v2
    v_exp_f32 v120, v120
    v_exp_f32 v121, v121
    v_exp_f32 v122, v122
    v_exp_f32 v123, v123
    v_smfmac_f32_32x32x32_bf16 v[64:79], v[228:231], v[152:159], v2
    s_waitcnt vmcnt(8)
    v_exp_f32 v124, v124
    v_exp_f32 v125, v125
    v_exp_f32 v126, v126
    v_exp_f32 v127, v127
    v_mfma_f32_32x32x16_bf16 v[144:159], v[200:203], v[16:19], 0
    global_load_dwordx4 v[192:195], v1, s[20:21] offset:-4096 sc1
    v_exp_f32 v128, v128
    v_exp_f32 v129, v129
    v_exp_f32 v130, v130
    v_exp_f32 v131, v131
    v_mfma_f32_32x32x16_bf16 v[144:159], v[204:207], v[20:23], v[144:159]
    global_load_dwordx4 v[196:199], v1, s[20:21] offset:-3072 sc1
    v_exp_f32 v132, v132
    v_exp_f32 v133, v133
    v_exp_f32 v134, v134
    v_exp_f32 v135, v135
    v_smfmac_f32_32x32x32_bf16 v[80:95], v[224:227], v[112:119], v2
    v_exp_f32 v136, v136
    v_exp_f32 v137, v137
    v_exp_f32 v138, v138
    v_exp_f32 v139, v139
    v_smfmac_f32_32x32x32_bf16 v[80:95], v[228:231], v[120:127], v2
    v_exp_f32 v140, v140
    v_exp_f32 v141, v141
    v_exp_f32 v142, v142
    v_exp_f32 v143, v143
    v_mfma_f32_32x32x16_bf16 v[112:127], v[200:203], v[24:27], 0
    v_exp_f32 v144, v144
    v_exp_f32 v145, v145
    v_exp_f32 v146, v146
    v_exp_f32 v147, v147
    v_mfma_f32_32x32x16_bf16 v[112:127], v[204:207], v[28:31], v[112:127]
    v_exp_f32 v148, v148
    v_exp_f32 v149, v149
    v_exp_f32 v150, v150
    v_exp_f32 v151, v151
    v_smfmac_f32_32x32x32_bf16 v[96:111], v[224:227], v[128:135], v2
    v_exp_f32 v152, v152
    v_exp_f32 v153, v153
    v_exp_f32 v154, v154
    v_exp_f32 v155, v155
    v_smfmac_f32_32x32x32_bf16 v[96:111], v[228:231], v[136:143], v2
    v_exp_f32 v156, v156
    v_exp_f32 v157, v157
    v_exp_f32 v158, v158
    v_exp_f32 v159, v159
    v_mfma_f32_32x32x16_bf16 v[128:143], v[200:203], v[32:35], 0
    global_load_dwordx4 v[224:227], v1, s[20:21] offset:-2048 sc1
    v_exp_f32 v112, v112
    v_exp_f32 v113, v113
    v_exp_f32 v114, v114
    v_exp_f32 v115, v115
    v_mfma_f32_32x32x16_bf16 v[128:143], v[204:207], v[36:39], v[128:143]
    global_load_dwordx4 v[228:231], v1, s[20:21] offset:-1024 sc1
    v_exp_f32 v116, v116
    v_exp_f32 v117, v117
    v_exp_f32 v118, v118
    v_exp_f32 v119, v119
    v_smfmac_f32_32x32x32_bf16 v[48:63], v[232:235], v[144:151], v2
    v_exp_f32 v120, v120
    v_exp_f32 v121, v121
    v_exp_f32 v122, v122
    v_exp_f32 v123, v123
    v_smfmac_f32_32x32x32_bf16 v[48:63], v[236:239], v[152:159], v2
    v_exp_f32 v124, v124
    v_exp_f32 v125, v125
    v_exp_f32 v126, v126
    v_exp_f32 v127, v127
    v_mfma_f32_32x32x16_bf16 v[144:159], v[200:203], v[40:43], 0
    v_exp_f32 v128, v128
    v_exp_f32 v129, v129
    v_exp_f32 v130, v130
    v_exp_f32 v131, v131
    v_mfma_f32_32x32x16_bf16 v[144:159], v[204:207], v[44:47], v[144:159]
    v_exp_f32 v132, v132
    v_exp_f32 v133, v133
    v_exp_f32 v134, v134
    v_exp_f32 v135, v135
    v_smfmac_f32_32x32x32_bf16 v[64:79], v[232:235], v[112:119], v2
    v_exp_f32 v136, v136
    v_exp_f32 v137, v137
    v_exp_f32 v138, v138
    v_exp_f32 v139, v139
    v_smfmac_f32_32x32x32_bf16 v[64:79], v[236:239], v[120:127], v2
    s_waitcnt vmcnt(8)
    v_exp_f32 v140, v140
    v_exp_f32 v141, v141
    v_exp_f32 v142, v142
    v_exp_f32 v143, v143
    v_mfma_f32_32x32x16_bf16 v[112:127], v[176:179], v[16:19], 0
    global_load_dwordx4 v[200:203], v1, s[20:21] offset:0 sc1
    v_exp_f32 v144, v144
    v_exp_f32 v145, v145
    v_exp_f32 v146, v146
    v_exp_f32 v147, v147
    v_mfma_f32_32x32x16_bf16 v[112:127], v[180:183], v[20:23], v[112:127]
    global_load_dwordx4 v[204:207], v1, s[20:21] offset:1024 sc1
    v_exp_f32 v148, v148
    v_exp_f32 v149, v149
    v_exp_f32 v150, v150
    v_exp_f32 v151, v151
    v_smfmac_f32_32x32x32_bf16 v[80:95], v[232:235], v[128:135], v2
    v_exp_f32 v152, v152
    v_exp_f32 v153, v153
    v_exp_f32 v154, v154
    v_exp_f32 v155, v155
    v_smfmac_f32_32x32x32_bf16 v[80:95], v[236:239], v[136:143], v2
    v_exp_f32 v156, v156
    v_exp_f32 v157, v157
    v_exp_f32 v158, v158
    v_exp_f32 v159, v159
    v_mfma_f32_32x32x16_bf16 v[128:143], v[176:179], v[24:27], 0
    v_exp_f32 v112, v112
    v_exp_f32 v113, v113
    v_exp_f32 v114, v114
    v_exp_f32 v115, v115
    v_mfma_f32_32x32x16_bf16 v[128:143], v[180:183], v[28:31], v[128:143]
    v_exp_f32 v116, v116
    v_exp_f32 v117, v117
    v_exp_f32 v118, v118
    v_exp_f32 v119, v119
    v_smfmac_f32_32x32x32_bf16 v[96:111], v[232:235], v[144:151], v2
    v_exp_f32 v120, v120
    v_exp_f32 v121, v121
    v_exp_f32 v122, v122
    v_exp_f32 v123, v123
    v_smfmac_f32_32x32x32_bf16 v[96:111], v[236:239], v[152:159], v2
    v_exp_f32 v124, v124
    v_exp_f32 v125, v125
    v_exp_f32 v126, v126
    v_exp_f32 v127, v127
    v_mfma_f32_32x32x16_bf16 v[144:159], v[176:179], v[32:35], 0
    global_load_dwordx4 v[232:235], v1, s[20:21] offset:2048 sc1
    v_exp_f32 v128, v128
    v_exp_f32 v129, v129
    v_exp_f32 v130, v130
    v_exp_f32 v131, v131
    v_mfma_f32_32x32x16_bf16 v[144:159], v[180:183], v[36:39], v[144:159]
    global_load_dwordx4 v[236:239], v1, s[20:21] offset:3072 sc1
    v_exp_f32 v132, v132
    v_exp_f32 v133, v133
    v_exp_f32 v134, v134
    v_exp_f32 v135, v135
    v_smfmac_f32_32x32x32_bf16 v[48:63], v[208:211], v[112:119], v2
    v_exp_f32 v136, v136
    v_exp_f32 v137, v137
    v_exp_f32 v138, v138
    v_exp_f32 v139, v139
    v_smfmac_f32_32x32x32_bf16 v[48:63], v[212:215], v[120:127], v2
    s_waitcnt vmcnt(8)
    v_exp_f32 v140, v140
    v_exp_f32 v141, v141
    v_exp_f32 v142, v142
    v_exp_f32 v143, v143
    v_mfma_f32_32x32x16_bf16 v[112:127], v[184:187], v[16:19], 0
    v_exp_f32 v144, v144
    v_exp_f32 v145, v145
    v_exp_f32 v146, v146
    v_exp_f32 v147, v147
    v_mfma_f32_32x32x16_bf16 v[112:127], v[188:191], v[20:23], v[112:127]
    v_exp_f32 v148, v148
    v_exp_f32 v149, v149
    v_exp_f32 v150, v150
    v_exp_f32 v151, v151
    v_smfmac_f32_32x32x32_bf16 v[64:79], v[208:211], v[128:135], v2
    v_exp_f32 v152, v152
    v_exp_f32 v153, v153
    v_exp_f32 v154, v154
    v_exp_f32 v155, v155
    v_smfmac_f32_32x32x32_bf16 v[64:79], v[212:215], v[136:143], v2
    v_exp_f32 v156, v156
    v_exp_f32 v157, v157
    v_exp_f32 v158, v158
    v_exp_f32 v159, v159
    v_mfma_f32_32x32x16_bf16 v[128:143], v[184:187], v[24:27], 0
    v_exp_f32 v112, v112
    v_exp_f32 v113, v113
    v_exp_f32 v114, v114
    v_exp_f32 v115, v115
    v_mfma_f32_32x32x16_bf16 v[128:143], v[188:191], v[28:31], v[128:143]
    v_exp_f32 v116, v116
    v_exp_f32 v117, v117
    v_exp_f32 v118, v118
    v_exp_f32 v119, v119
    v_smfmac_f32_32x32x32_bf16 v[80:95], v[208:211], v[144:151], v2
    v_exp_f32 v120, v120
    v_exp_f32 v121, v121
    v_exp_f32 v122, v122
    v_exp_f32 v123, v123
    v_smfmac_f32_32x32x32_bf16 v[80:95], v[212:215], v[152:159], v2
    v_exp_f32 v124, v124
    v_exp_f32 v125, v125
    v_exp_f32 v126, v126
    v_exp_f32 v127, v127
    v_mfma_f32_32x32x16_bf16 v[144:159], v[184:187], v[32:35], 0
    v_exp_f32 v128, v128
    v_exp_f32 v129, v129
    v_exp_f32 v130, v130
    v_exp_f32 v131, v131
    v_mfma_f32_32x32x16_bf16 v[144:159], v[188:191], v[36:39], v[144:159]
    v_exp_f32 v132, v132
    v_exp_f32 v133, v133
    v_exp_f32 v134, v134
    v_exp_f32 v135, v135
    v_smfmac_f32_32x32x32_bf16 v[48:63], v[216:219], v[112:119], v2
    v_exp_f32 v136, v136
    v_exp_f32 v137, v137
    v_exp_f32 v138, v138
    v_exp_f32 v139, v139
    v_smfmac_f32_32x32x32_bf16 v[48:63], v[220:223], v[120:127], v2
    s_waitcnt vmcnt(4)
    v_exp_f32 v140, v140
    v_exp_f32 v141, v141
    v_exp_f32 v142, v142
    v_exp_f32 v143, v143
    v_mfma_f32_32x32x16_bf16 v[112:127], v[192:195], v[16:19], 0
    v_exp_f32 v144, v144
    v_exp_f32 v145, v145
    v_exp_f32 v146, v146
    v_exp_f32 v147, v147
    v_mfma_f32_32x32x16_bf16 v[112:127], v[196:199], v[20:23], v[112:127]
    v_exp_f32 v148, v148
    v_exp_f32 v149, v149
    v_exp_f32 v150, v150
    v_exp_f32 v151, v151
    v_smfmac_f32_32x32x32_bf16 v[64:79], v[216:219], v[128:135], v2
    v_exp_f32 v152, v152
    v_exp_f32 v153, v153
    v_exp_f32 v154, v154
    v_exp_f32 v155, v155
    v_smfmac_f32_32x32x32_bf16 v[64:79], v[220:223], v[136:143], v2
    s_waitcnt vmcnt(0)
    v_exp_f32 v156, v156
    v_exp_f32 v157, v157
    v_exp_f32 v158, v158
    v_exp_f32 v159, v159
    v_mfma_f32_32x32x16_bf16 v[128:143], v[200:203], v[16:19], 0
    v_exp_f32 v112, v112
    v_exp_f32 v113, v113
    v_exp_f32 v114, v114
    v_exp_f32 v115, v115
    v_mfma_f32_32x32x16_bf16 v[128:143], v[204:207], v[20:23], v[128:143]
    v_exp_f32 v116, v116
    v_exp_f32 v117, v117
    v_exp_f32 v118, v118
    v_exp_f32 v119, v119
    v_smfmac_f32_32x32x32_bf16 v[80:95], v[216:219], v[144:151], v2
    v_exp_f32 v120, v120
    v_exp_f32 v121, v121
    v_exp_f32 v122, v122
    v_exp_f32 v123, v123
    v_smfmac_f32_32x32x32_bf16 v[80:95], v[220:223], v[152:159], v2
    s_cmp_lg_u32 s46, 3
    s_cbranch_scc1 L_wbp
    s_cmp_lg_u32 s41, 3
    s_cbranch_scc1 L_wbp
    buffer_wbl2 sc1
L_wbp:
    v_exp_f32 v124, v124
    v_exp_f32 v125, v125
    v_exp_f32 v126, v126
    v_exp_f32 v127, v127
    v_mfma_f32_32x32x16_bf16 v[144:159], v[192:195], v[24:27], 0
    v_exp_f32 v128, v128
    v_exp_f32 v129, v129
    v_exp_f32 v130, v130
    v_exp_f32 v131, v131
    v_mfma_f32_32x32x16_bf16 v[144:159], v[196:199], v[28:31], v[144:159]
    v_exp_f32 v132, v132
    v_exp_f32 v133, v133
    v_exp_f32 v134, v134
    v_exp_f32 v135, v135
    v_smfmac_f32_32x32x32_bf16 v[48:63], v[224:227], v[112:119], v2
    v_exp_f32 v136, v136
    v_exp_f32 v137, v137
    v_exp_f32 v138, v138
    v_exp_f32 v139, v139
    v_smfmac_f32_32x32x32_bf16 v[48:63], v[228:231], v[120:127], v2
    v_exp_f32 v140, v140
    v_exp_f32 v141, v141
    v_exp_f32 v142, v142
    v_exp_f32 v143, v143
    v_mfma_f32_32x32x16_bf16 v[112:127], v[200:203], v[24:27], 0
    v_exp_f32 v144, v144
    v_exp_f32 v145, v145
    v_exp_f32 v146, v146
    v_exp_f32 v147, v147
    v_mfma_f32_32x32x16_bf16 v[112:127], v[204:207], v[28:31], v[112:127]
    v_exp_f32 v148, v148
    v_exp_f32 v149, v149
    v_exp_f32 v150, v150
    v_exp_f32 v151, v151
    v_smfmac_f32_32x32x32_bf16 v[48:63], v[232:235], v[128:135], v2
    v_exp_f32 v152, v152
    v_exp_f32 v153, v153
    v_exp_f32 v154, v154
    v_exp_f32 v155, v155
    v_smfmac_f32_32x32x32_bf16 v[48:63], v[236:239], v[136:143], v2
    v_exp_f32 v156, v156
    v_exp_f32 v157, v157
    v_exp_f32 v158, v158
    v_exp_f32 v159, v159
    v_mfma_f32_32x32x16_bf16 v[128:143], v[192:195], v[32:35], 0
    v_exp_f32 v112, v112
    v_exp_f32 v113, v113
    v_exp_f32 v114, v114
    v_exp_f32 v115, v115
    v_mfma_f32_32x32x16_bf16 v[128:143], v[196:199], v[36:39], v[128:143]
    v_exp_f32 v116, v116
    v_exp_f32 v117, v117
    v_exp_f32 v118, v118
    v_exp_f32 v119, v119
    v_smfmac_f32_32x32x32_bf16 v[64:79], v[224:227], v[144:151], v2
    ds_write_b128 v11, v[48:51] offset:0
    v_exp_f32 v120, v120
    v_exp_f32 v121, v121
    v_exp_f32 v122, v122
    v_exp_f32 v123, v123
    v_smfmac_f32_32x32x32_bf16 v[64:79], v[228:231], v[152:159], v2
    ds_write_b128 v11, v[52:55] offset:1024
    v_exp_f32 v124, v124
    v_exp_f32 v125, v125
    v_exp_f32 v126, v126
    v_exp_f32 v127, v127
    v_mfma_f32_32x32x16_bf16 v[144:159], v[200:203], v[32:35], 0
    ds_write_b128 v11, v[56:59] offset:2048
    v_exp_f32 v128, v128
    v_exp_f32 v129, v129
    v_exp_f32 v130, v130
    v_exp_f32 v131, v131
    v_mfma_f32_32x32x16_bf16 v[144:159], v[204:207], v[36:39], v[144:159]
    ds_write_b128 v11, v[60:63] offset:3072
    v_exp_f32 v132, v132
    v_exp_f32 v133, v133
    v_exp_f32 v134, v134
    v_exp_f32 v135, v135
    v_smfmac_f32_32x32x32_bf16 v[64:79], v[232:235], v[112:119], v2
    v_exp_f32 v136, v136
    v_exp_f32 v137, v137
    v_exp_f32 v138, v138
    v_exp_f32 v139, v139
    v_smfmac_f32_32x32x32_bf16 v[64:79], v[236:239], v[120:127], v2
    v_exp_f32 v140, v140
    v_exp_f32 v141, v141
    v_exp_f32 v142, v142
    v_exp_f32 v143, v143
    v_mfma_f32_32x32x16_bf16 v[112:127], v[176:179], v[40:43], 0
    v_exp_f32 v144, v144
    v_exp_f32 v145, v145
    v_exp_f32 v146, v146
    v_exp_f32 v147, v147
    v_mfma_f32_32x32x16_bf16 v[112:127], v[180:183], v[44:47], v[112:127]
    v_exp_f32 v148, v148
    v_exp_f32 v149, v149
    v_exp_f32 v150, v150
    v_exp_f32 v151, v151
    v_smfmac_f32_32x32x32_bf16 v[80:95], v[224:227], v[128:135], v2
    ds_write_b128 v12, v[64:67] offset:0
    v_exp_f32 v152, v152
    v_exp_f32 v153, v153
    v_exp_f32 v154, v154
    v_exp_f32 v155, v155
    v_smfmac_f32_32x32x32_bf16 v[80:95], v[228:231], v[136:143], v2
    ds_write_b128 v12, v[68:71] offset:1024
    v_exp_f32 v156, v156
    v_exp_f32 v157, v157
    v_exp_f32 v158, v158
    v_exp_f32 v159, v159
    v_mfma_f32_32x32x16_bf16 v[128:143], v[184:187], v[40:43], 0
    ds_write_b128 v12, v[72:75] offset:2048
    v_exp_f32 v112, v112
    v_exp_f32 v113, v113
    v_exp_f32 v114, v114
    v_exp_f32 v115, v115
    v_mfma_f32_32x32x16_bf16 v[128:143], v[188:191], v[44:47], v[128:143]
    ds_write_b128 v12, v[76:79] offset:3072
    v_exp_f32 v116, v116
    v_exp_f32 v117, v117
    v_exp_f32 v118, v118
    v_exp_f32 v119, v119
    v_smfmac_f32_32x32x32_bf16 v[80:95], v[232:235], v[144:151], v2
    v_exp_f32 v120, v120
    v_exp_f32 v121, v121
    v_exp_f32 v122, v122
    v_exp_f32 v123, v123
    v_smfmac_f32_32x32x32_bf16 v[80:95], v[236:239], v[152:159], v2
    v_exp_f32 v124, v124
    v_exp_f32 v125, v125
    v_exp_f32 v126, v126
    v_exp_f32 v127, v127
    v_mfma_f32_32x32x16_bf16 v[144:159], v[192:195], v[40:43], 0
    v_exp_f32 v128, v128
    v_exp_f32 v129, v129
    v_exp_f32 v130, v130
    v_exp_f32 v131, v131
    v_mfma_f32_32x32x16_bf16 v[144:159], v[196:199], v[44:47], v[144:159]
    v_exp_f32 v132, v132
    v_exp_f32 v133, v133
    v_exp_f32 v134, v134
    v_exp_f32 v135, v135
    v_smfmac_f32_32x32x32_bf16 v[96:111], v[208:211], v[112:119], v2
    ds_write_b128 v13, v[80:83] offset:0
    v_exp_f32 v136, v136
    v_exp_f32 v137, v137
    v_exp_f32 v138, v138
    v_exp_f32 v139, v139
    v_smfmac_f32_32x32x32_bf16 v[96:111], v[212:215], v[120:127], v2
    ds_write_b128 v13, v[84:87] offset:1024
    v_exp_f32 v140, v140
    v_exp_f32 v141, v141
    v_exp_f32 v142, v142
    v_exp_f32 v143, v143
    v_mfma_f32_32x32x16_bf16 v[112:127], v[200:203], v[40:43], 0
    ds_write_b128 v13, v[88:91] offset:2048
    v_exp_f32 v144, v144
    v_exp_f32 v145, v145
    v_exp_f32 v146, v146
    v_exp_f32 v147, v147
    v_mfma_f32_32x32x16_bf16 v[112:127], v[204:207], v[44:47], v[112:127]
    ds_write_b128 v13, v[92:95] offset:3072
    s_mov_b64 exec, 1
    ds_add_u32 v3, v5 offset:0
    s_mov_b64 exec, -1
    v_exp_f32 v148, v148
    v_exp_f32 v149, v149
    v_exp_f32 v150, v150
    v_exp_f32 v151, v151
    v_smfmac_f32_32x32x32_bf16 v[96:111], v[216:219], v[128:135], v2
    v_exp_f32 v152, v152
    v_exp_f32 v153, v153
    v_exp_f32 v154, v154
    v_exp_f32 v155, v155
    v_smfmac_f32_32x32x32_bf16 v[96:111], v[220:223], v[136:143], v2
    s_mov_b32 s63, 4194304
    ds_read_b32 v253, v3
    v_exp_f32 v156, v156
    v_exp_f32 v157, v157
    v_exp_f32 v158, v158
    v_exp_f32 v159, v159
    v_exp_f32 v112, v112
    v_exp_f32 v113, v113
    v_exp_f32 v114, v114
    v_exp_f32 v115, v115
L_p_re:
    s_waitcnt lgkmcnt(0)
    v_readfirstlane_b32 s61, v253
    s_sub_u32 s63, s63, 1
    ds_read_b32 v253, v3
    s_cbranch_scc1 L_end
    s_cmp_ge_u32 s61, 8
    s_cbranch_scc0 L_p_re
L_p_back:
    ds_read_b128 v[48:51], v14 offset:0
    ds_read_b128 v[52:55], v14 offset:1024
    ds_read_b128 v[56:59], v14 offset:2048
    ds_read_b128 v[60:63], v14 offset:3072
    v_exp_f32 v116, v116
    v_exp_f32 v117, v117
    v_exp_f32 v118, v118
    v_exp_f32 v119, v119
    v_smfmac_f32_32x32x32_bf16 v[96:111], v[224:227], v[144:151], v2
    ds_read_b128 v[64:67], v14 offset:4096
    ds_read_b128 v[68:71], v14 offset:5120
    ds_read_b128 v[72:75], v14 offset:6144
    ds_read_b128 v[76:79], v14 offset:7168
    v_exp_f32 v120, v120
    v_exp_f32 v121, v121
    v_exp_f32 v122, v122
    v_exp_f32 v123, v123
    v_smfmac_f32_32x32x32_bf16 v[96:111], v[228:231], v[152:159], v2
    ds_read_b128 v[80:83], v14 offset:8192
    ds_read_b128 v[84:87], v14 offset:9216
    ds_read_b128 v[88:91], v14 offset:10240
    ds_read_b128 v[92:95], v14 offset:11264
    v_exp_f32 v124, v124
    v_exp_f32 v125, v125
    v_exp_f32 v126, v126
    v_exp_f32 v127, v127
    s_nop 1
    v_smfmac_f32_32x32x32_bf16 v[96:111], v[232:235], v[112:119], v2
    v_smfmac_f32_32x32x32_bf16 v[96:111], v[236:239], v[120:127], v2
    s_waitcnt lgkmcnt(0)
    v_add_f32 v48, v48, v64
    v_add_f32 v49, v49, v65
    v_add_f32 v50, v50, v66
    v_add_f32 v51, v51, v67
    v_add_f32 v52, v52, v68
    v_add_f32 v53, v53, v69
    v_add_f32 v54, v54, v70
    v_add_f32 v55, v55, v71
    v_add_f32 v56, v56, v72
    v_add_f32 v57, v57, v73
    v_add_f32 v58, v58, v74
    v_add_f32 v59, v59, v75
    v_add_f32 v60, v60, v76
    v_add_f32 v61, v61, v77
    v_add_f32 v62, v62, v78
    v_add_f32 v63, v63, v79
    v_add_f32 v48, v48, v80
    v_add_f32 v49, v49, v81
    v_add_f32 v50, v50, v82
    v_add_f32 v51, v51, v83
    v_add_f32 v52, v52, v84
    v_add_f32 v53, v53, v85
    v_add_f32 v54, v54, v86
    v_add_f32 v55, v55, v87
    v_add_f32 v56, v56, v88
    v_add_f32 v57, v57, v89
    v_add_f32 v58, v58, v90
    v_add_f32 v59, v59, v91
    v_add_f32 v60, v60, v92
    v_add_f32 v61, v61, v93
    v_add_f32 v62, v62, v94
    v_add_f32 v63, v63, v95
    v_add_f32 v108, v108, v60
    v_mov_b32 v240, v108
    v_mov_b32 v241, v108
    v_add_f32 v96, v96, v48
    v_add_f32 v97, v97, v49
    v_add_f32 v98, v98, v50
    v_add_f32 v99, v99, v51
    v_permlane32_swap_b32 v240, v241
    v_add_f32 v100, v100, v52
    v_add_f32 v101, v101, v53
    v_add_f32 v102, v102, v54
    v_add_f32 v103, v103, v55
    v_add_f32 v104, v104, v56
    v_add_f32 v105, v105, v57
    v_add_f32 v106, v106, v58
    v_add_f32 v107, v107, v59
    v_add_f32 v109, v109, v61
    v_add_f32 v110, v110, v62
    v_add_f32 v111, v111, v63
    s_mov_b32 s23, 0
L_norm:
    v_rcp_f32 v240, v241
    buffer_load_dwordx2 v[254:255], v163, s[12:15], 0 offen sc1
    v_mul_f32 v96, v96, v240
    v_mul_f32 v97, v97, v240
    v_mul_f32 v98, v98, v240
    v_mul_f32 v99, v99, v240
    v_mul_f32 v100, v100, v240
    v_mul_f32 v101, v101, v240
    v_mul_f32 v102, v102, v240
    v_mul_f32 v103, v103, v240
    v_cvt_pk_bf16_f32 v244, v96, v97
    v_cvt_pk_bf16_f32 v245, v98, v99
    v_cvt_pk_bf16_f32 v246, v100, v101
    v_cvt_pk_bf16_f32 v247, v102, v103
    buffer_store_dwordx4 v[244:247], v1, s[12:15], s19 offen sc1
    v_mul_f32 v104, v104, v240
    v_mul_f32 v105, v105, v240
    v_mul_f32 v106, v106, v240
    v_mul_f32 v107, v107, v240
    v_mul_f32 v108, v108, v240
    v_mul_f32 v109, v109, v240
    v_mul_f32 v110, v110, v240
    v_mul_f32 v111, v111, v240
    v_cvt_pk_bf16_f32 v248, v104, v105
    v_cvt_pk_bf16_f32 v249, v106, v107
    v_cvt_pk_bf16_f32 v250, v108, v109
    v_cvt_pk_bf16_f32 v251, v110, v111
    s_mov_b32 exec_hi, 0
    buffer_store_dwordx4 v[248:251], v1, s[12:15], s19 offen offset:1024 sc1
    s_not_b64 exec, exec
    buffer_store_dwordx2 v[248:249], v6, s[12:15], s19 offen offset:1280 sc1
    s_mov_b64 exec, -1
    s_cmp_lg_u32 s23, 0
    s_cbranch_scc1 L_checked
    s_mov_b64 exec, 1
    ds_add_u32 v3, v5 offset:0
    s_mov_b64 exec, -1
    v_maximum3_f32 v242, |v96|, |v97|, v241
    v_maximum3_f32 v242, |v98|, |v99|, v242
    v_maximum3_f32 v242, |v100|, |v101|, v242
    v_maximum3_f32 v242, |v102|, |v103|, v242
    v_maximum3_f32 v242, |v104|, |v105|, v242
    v_maximum3_f32 v242, |v106|, |v107|, v242
    v_maximum3_f32 v242, |v108|, |v109|, v242
    v_maximum3_f32 v242, |v110|, |v111|, v242
    v_cmp_nlt_f32 vcc, 0x35800000, v241
    s_mov_b64 s[62:63], vcc
    v_cmp_ngt_f32 vcc, 0x71800000, v242
    s_or_b64 vcc, vcc, s[62:63]
    s_cbranch_vccnz L_fallback
L_checked:
    s_cmp_eq_u32 s50, 0
    s_cbranch_scc1 L_wfirst
L_pub:
    ds_read_b64 v[252:253], v165
    v_mov_b32 v242, s76
    v_mov_b32 v243, s77
    s_mov_b64 exec, 1
    s_cmp_eq_u32 s50, 0
    s_waitcnt vmcnt(0)
    buffer_store_dwordx2 v[242:243], off, s[12:15], s22 sc1
    s_mov_b64 exec, -1
    s_cbranch_scc1 L_ph3
    s_waitcnt lgkmcnt(0)
    v_readfirstlane_b32 s58, v252
    v_readfirstlane_b32 s59, v253
    s_cmp_eq_u32 s56, 3
    s_cselect_b32 s59, s59, 12
    s_add_u32 s59, s59, 4
    s_min_u32 s58, s58, s59
    s_cmp_ge_u32 s58, 16
    s_cbranch_scc1 L_pfree_done
    s_mov_b32 s63, 4194304
L_wfree_spin:
    ds_read_b32 v253, v165 offset:0
    s_sub_u32 s63, s63, 1
    s_cbranch_scc1 L_end
    s_waitcnt lgkmcnt(0)
    v_readfirstlane_b32 s61, v253
    s_cmp_ge_u32 s61, 16
    s_cbranch_scc1 L_wfree_done
    s_sleep 1
    s_branch L_wfree_spin
L_wfree_done:
    s_mov_b32 s63, 4194304
L_pfree_spin:
    ds_read_b32 v253, v3 offset:0
    s_sub_u32 s63, s63, 1
    s_cbranch_scc1 L_end
    s_waitcnt lgkmcnt(0)
    v_readfirstlane_b32 s61, v253
    s_cmp_ge_u32 s61, 12
    s_cbranch_scc1 L_pfree_done
    s_sleep 1
    s_branch L_pfree_spin
L_pfree_done:
    v_cmp_ne_u64 vcc, s[76:77], v[254:255]
    s_cbranch_vccz L_lready
    s_waitcnt vmcnt(0)
    s_mov_b32 s63, 4194304
    s_mov_b64 exec, 0xf
L_f21_spin:
    buffer_load_dwordx2 v[254:255], v163, s[12:15], 0 offen sc1
    s_sub_u32 s63, s63, 1
    s_cbranch_scc1 L_end
    s_waitcnt vmcnt(0)
    v_cmp_ne_u64 vcc, s[76:77], v[254:255]
    s_cbranch_vccnz L_f21_spin
    s_mov_b64 exec, -1
L_lready:
    s_mov_b32 m0, s51
    s_nop 0
    buffer_load_dwordx4 v1, s[12:15], s43 offen offset:0 sc1 lds
    buffer_load_dwordx4 v1, s[12:15], s43 offen offset:1024 sc1 lds
    buffer_load_dwordx4 v1, s[12:15], s43 offen offset:2048 sc1 lds
    buffer_load_dwordx4 v1, s[12:15], s43 offen offset:3072 sc1 lds
    s_add_u32 m0, s51, 4096
    s_nop 0
    buffer_load_dwordx4 v1, s[12:15], s57 offen offset:0 sc1 lds
    buffer_load_dwordx4 v1, s[12:15], s57 offen offset:1024 sc1 lds
    buffer_load_dwordx4 v1, s[12:15], s57 offen offset:2048 sc1 lds
    s_mov_b64 exec, 1
    s_waitcnt vmcnt(0)
    ds_write_b32 v164, v5
    s_mov_b64 exec, -1
    s_waitcnt lgkmcnt(0)
    s_branch L_fin
L_ph3:
    v_xor_b32 v8, 64, v160
    v_xor_b32 v9, 64, v161
    v_xor_b32 v10, 64, v162
    v_xor_b32 v11, 16, v166
    v_xor_b32 v12, 64, v166
    v_xor_b32 v13, 80, v166
    s_mov_b64 exec, 1
    ds_add_u32 v3, v5 offset:0
    s_mov_b64 exec, -1
    s_mov_b32 s63, 4194304
L_g4_spin:
    ds_read_b32 v253, v3 offset:0
    s_sub_u32 s63, s63, 1
    s_cbranch_scc1 L_end
    s_waitcnt lgkmcnt(0)
    v_readfirstlane_b32 s61, v253
    s_cmp_ge_u32 s61, 16
    s_cbranch_scc1 L_g4_done
    s_sleep 2
    s_branch L_g4_spin
L_g4_done:
    ds_read_b64_tr_b16 v[16:17], v160 offset:0
    ds_read_b64_tr_b16 v[18:19], v160 offset:2048
    ds_read_b64_tr_b16 v[20:21], v8 offset:0
    ds_read_b64_tr_b16 v[22:23], v8 offset:2048
    ds_read_b64_tr_b16 v[24:25], v160 offset:7168
    ds_read_b64_tr_b16 v[26:27], v160 offset:9216
    ds_read_b64_tr_b16 v[28:29], v8 offset:7168
    ds_read_b64_tr_b16 v[30:31], v8 offset:9216
    ds_read_b64_tr_b16 v[32:33], v160 offset:14336
    ds_read_b64_tr_b16 v[34:35], v160 offset:16384
    ds_read_b64_tr_b16 v[36:37], v8 offset:14336
    ds_read_b64_tr_b16 v[38:39], v8 offset:16384
    ds_read_b64_tr_b16 v[40:41], v160 offset:21504
    ds_read_b64_tr_b16 v[42:43], v160 offset:23552
    ds_read_b64_tr_b16 v[44:45], v8 offset:21504
    ds_read_b64_tr_b16 v[46:47], v8 offset:23552
    ds_read_b64_tr_b16 v[48:49], v161 offset:4096
    ds_read_b64_tr_b16 v[50:51], v161 offset:6144
    ds_read_b64_tr_b16 v[52:53], v9 offset:4096
    ds_read_b64_tr_b16 v[54:55], v9 offset:6144
    ds_read_b64_tr_b16 v[56:57], v161 offset:18432
    ds_read_b64_tr_b16 v[58:59], v161 offset:20480
    ds_read_b64_tr_b16 v[60:61], v9 offset:18432
    ds_read_b64_tr_b16 v[62:63], v9 offset:20480
    ds_read_b64_tr_b16 v[64:65], v162 offset:5120
    ds_read_b64_tr_b16 v[66:67], v162 offset:12288
    ds_read_b64_tr_b16 v[68:69], v10 offset:5120
    ds_read_b64_tr_b16 v[70:71], v10 offset:12288
    ds_read_b64_tr_b16 v[72:73], v160 offset:28672
    ds_read_b64_tr_b16 v[74:75], v160 offset:30720
    ds_read_b64_tr_b16 v[76:77], v8 offset:28672
    ds_read_b64_tr_b16 v[78:79], v8 offset:30720
    ds_read_b64_tr_b16 v[80:81], v160 offset:35840
    ds_read_b64_tr_b16 v[82:83], v160 offset:37888
    ds_read_b64_tr_b16 v[84:85], v8 offset:35840
    ds_read_b64_tr_b16 v[86:87], v8 offset:37888
    ds_read_b64_tr_b16 v[88:89], v160 offset:43008
    ds_read_b64_tr_b16 v[90:91], v160 offset:45056
    ds_read_b64_tr_b16 v[92:93], v8 offset:43008
    ds_read_b64_tr_b16 v[94:95], v8 offset:45056
    ds_read_b64_tr_b16 v[96:97], v160 offset:50176
    ds_read_b64_tr_b16 v[98:99], v160 offset:52224
    ds_read_b64_tr_b16 v[100:101], v8 offset:50176
    ds_read_b64_tr_b16 v[102:103], v8 offset:52224
    ds_read_b64_tr_b16 v[104:105], v161 offset:32768
    ds_read_b64_tr_b16 v[106:107], v161 offset:34816
    ds_read_b64_tr_b16 v[108:109], v9 offset:32768
    ds_read_b64_tr_b16 v[110:111], v9 offset:34816
    ds_read_b64_tr_b16 v[112:113], v161 offset:47104
    ds_read_b64_tr_b16 v[114:115], v161 offset:49152
    ds_read_b64_tr_b16 v[116:117], v9 offset:47104
    ds_read_b64_tr_b16 v[118:119], v9 offset:49152
    ds_read_b64_tr_b16 v[120:121], v162 offset:33792
    ds_read_b64_tr_b16 v[122:123], v162 offset:40960
    ds_read_b64_tr_b16 v[124:125], v10 offset:33792
    ds_read_b64_tr_b16 v[126:127], v10 offset:40960
    s_waitcnt lgkmcnt(0)
    s_mov_b64 exec, 1
    ds_add_u32 v3, v5 offset:0
    s_mov_b64 exec, -1
    s_mov_b32 s63, 4194304
L_g5_spin:
    ds_read_b32 v253, v3 offset:0
    s_sub_u32 s63, s63, 1
    s_cbranch_scc1 L_end
    s_waitcnt lgkmcnt(0)
    v_readfirstlane_b32 s61, v253
    s_cmp_ge_u32 s61, 20
    s_cbranch_scc1 L_g5_done
    s_sleep 2
    s_branch L_g5_spin
L_g5_done:
    s_xor_b32 s58, s11, 1
    s_add_u32 s58, s58, s27
    s_mul_i32 s17, s58, 25088
    s_mul_i32 s18, s56, 14336
    s_mov_b32 s59, 0
    s_setprio 0
L_wo1:
    s_mov_b32 m0, s18
    s_add_u32 s59, s59, 1
    buffer_load_dwordx4 v172, s[36:39], s17 offen  lds
    s_add_u32 s18, s18, 1024
    s_cmp_eq_u32 s59, 7
    s_mov_b32 s58, 3584
    s_cselect_b32 s58, 28672, s58
    s_add_u32 s17, s17, s58
    s_cmp_lg_u32 s59, 14
    s_waitcnt vmcnt(5)
    s_cbranch_scc1 L_wo1
    s_waitcnt vmcnt(0)
    s_setprio 2
    s_mul_i32 s25, s7, 1792
    s_mul_i32 s26, s56, 7168
    s_add_u32 s26, s26, 57344
    s_mov_b32 s63, 4194304
    s_mov_b64 exec, 0xf
L_f20_spin:
    buffer_load_dwordx2 v[254:255], v173, s[12:15], 0 offen sc1
    s_sub_u32 s63, s63, 1
    s_cbranch_scc1 L_end
    s_waitcnt vmcnt(0)
    v_cmp_ne_u64 vcc, s[76:77], v[254:255]
    s_cbranch_vccnz L_f20_spin
    s_mov_b64 exec, -1
    s_mov_b32 m0, s26
    s_add_u32 s58, s25, 4096
    buffer_load_dwordx4 v1, s[12:15], s25 offen offset:0 sc1 lds
    buffer_load_dwordx4 v1, s[12:15], s25 offen offset:1024 sc1 lds
    buffer_load_dwordx4 v1, s[12:15], s25 offen offset:2048 sc1 lds
    buffer_load_dwordx4 v1, s[12:15], s25 offen offset:3072 sc1 lds
    s_add_u32 m0, s26, 4096
    s_nop 0
    buffer_load_dwordx4 v1, s[12:15], s58 offen offset:0 sc1 lds
    buffer_load_dwordx4 v1, s[12:15], s58 offen offset:1024 sc1 lds
    buffer_load_dwordx4 v1, s[12:15], s58 offen offset:2048 sc1 lds
    s_waitcnt vmcnt(0)
    s_mov_b64 exec, 1
    ds_add_u32 v3, v5 offset:0
    s_mov_b64 exec, -1
    s_mov_b32 s63, 4194304
L_g6_spin:
    ds_read_b32 v253, v3 offset:0
    s_sub_u32 s63, s63, 1
    s_cbranch_scc1 L_end
    s_waitcnt lgkmcnt(0)
    v_readfirstlane_b32 s61, v253
    s_cmp_ge_u32 s61, 24
    s_cbranch_scc1 L_g6_done
    s_sleep 2
    s_branch L_g6_spin
L_g6_done:
    s_cmp_eq_u32 s4, 0
    s_cbranch_scc1 L_fin
    ds_read_b128 v[176:179], v168 offset:0
    ds_read_b128 v[180:183], v168 offset:1792
    ds_read_b128 v[184:187], v168 offset:3584
    ds_read_b128 v[188:191], v168 offset:5376
    ds_read_b128 v[192:195], v169 offset:1024
    ds_read_b128 v[196:199], v169 offset:4608
    ds_read_b64 v[200:201], v170 offset:1536
    ds_read_b64 v[202:203], v170 offset:3328
    ds_read_b128 v[204:207], v168 offset:7168
    ds_read_b128 v[208:211], v168 offset:8960
    ds_read_b128 v[212:215], v168 offset:10752
    ds_read_b128 v[216:219], v168 offset:12544
    ds_read_b128 v[220:223], v169 offset:8192
    ds_read_b128 v[224:227], v169 offset:11776
    ds_read_b64 v[228:229], v170 offset:8704
    ds_read_b64 v[230:231], v170 offset:10496
    s_add_u32 s58, s8, 14336
    s_add_u32 s59, s8, 28672
    s_add_u32 s25, s8, 43008
    s_mov_b32 s63, 4194304
L_h3_spin:
    ds_read_b32 v253, v3 offset:4
    s_sub_u32 s63, s63, 1
    s_cbranch_scc1 L_end
    s_waitcnt lgkmcnt(0)
    v_readfirstlane_b32 s61, v253
    s_cmp_ge_u32 s61, 12
    s_cbranch_scc1 L_h3_done
    s_sleep 4
    s_branch L_h3_spin
L_h3_done:
    s_setprio 0
    v_mfma_f32_32x32x16_bf16 v[128:143], v[16:19], v[176:179], 0
    ds_read_b64_tr_b16 v[16:17], v160 offset:0
    ds_read_b64_tr_b16 v[18:19], v160 offset:2048
    v_mfma_f32_32x32x16_bf16 v[144:159], v[20:23], v[176:179], 0
    ds_read_b64_tr_b16 v[20:21], v8 offset:0
    ds_read_b64_tr_b16 v[22:23], v8 offset:2048
    v_mfma_f32_32x32x16_bf16 v[128:143], v[24:27], v[180:183], v[128:143]
    ds_read_b64_tr_b16 v[24:25], v160 offset:7168
    ds_read_b64_tr_b16 v[26:27], v160 offset:9216
    v_mfma_f32_32x32x16_bf16 v[144:159], v[28:31], v[180:183], v[144:159]
    ds_read_b64_tr_b16 v[28:29], v8 offset:7168
    ds_read_b64_tr_b16 v[30:31], v8 offset:9216
    v_mfma_f32_32x32x16_bf16 v[128:143], v[32:35], v[184:187], v[128:143]
    ds_read_b64_tr_b16 v[32:33], v160 offset:14336
    ds_read_b64_tr_b16 v[34:35], v160 offset:16384
    v_mfma_f32_32x32x16_bf16 v[144:159], v[36:39], v[184:187], v[144:159]
    ds_read_b64_tr_b16 v[36:37], v8 offset:14336
    ds_read_b64_tr_b16 v[38:39], v8 offset:16384
    v_mfma_f32_32x32x16_bf16 v[128:143], v[40:43], v[188:191], v[128:143]
    ds_read_b64_tr_b16 v[40:41], v160 offset:21504
    ds_read_b64_tr_b16 v[42:43], v160 offset:23552
    v_mfma_f32_32x32x16_bf16 v[144:159], v[44:47], v[188:191], v[144:159]
    ds_read_b64_tr_b16 v[44:45], v8 offset:21504
    ds_read_b64_tr_b16 v[46:47], v8 offset:23552
    v_mfma_f32_32x32x16_bf16 v[128:143], v[48:51], v[192:195], v[128:143]
    ds_read_b64_tr_b16 v[48:49], v161 offset:4096
    ds_read_b64_tr_b16 v[50:51], v161 offset:6144
    v_mfma_f32_32x32x16_bf16 v[144:159], v[52:55], v[192:195], v[144:159]
    ds_read_b64_tr_b16 v[52:53], v9 offset:4096
    ds_read_b64_tr_b16 v[54:55], v9 offset:6144
    v_mfma_f32_32x32x16_bf16 v[128:143], v[56:59], v[196:199], v[128:143]
    ds_read_b64_tr_b16 v[56:57], v161 offset:18432
    ds_read_b64_tr_b16 v[58:59], v161 offset:20480
    v_mfma_f32_32x32x16_bf16 v[144:159], v[60:63], v[196:199], v[144:159]
    ds_read_b64_tr_b16 v[60:61], v9 offset:18432
    ds_read_b64_tr_b16 v[62:63], v9 offset:20480
    v_mfma_f32_32x32x16_bf16 v[128:143], v[64:67], v[200:203], v[128:143]
    ds_read_b64_tr_b16 v[64:65], v162 offset:5120
    ds_read_b64_tr_b16 v[66:67], v162 offset:12288
    v_mfma_f32_32x32x16_bf16 v[144:159], v[68:71], v[200:203], v[144:159]
    ds_read_b64_tr_b16 v[68:69], v10 offset:5120
    ds_read_b64_tr_b16 v[70:71], v10 offset:12288
    v_mfma_f32_32x32x16_bf16 v[128:143], v[72:75], v[204:207], v[128:143]
    ds_read_b64_tr_b16 v[72:73], v160 offset:28672
    ds_read_b64_tr_b16 v[74:75], v160 offset:30720
    v_mfma_f32_32x32x16_bf16 v[144:159], v[76:79], v[204:207], v[144:159]
    ds_read_b64_tr_b16 v[76:77], v8 offset:28672
    ds_read_b64_tr_b16 v[78:79], v8 offset:30720
    v_mfma_f32_32x32x16_bf16 v[128:143], v[80:83], v[208:211], v[128:143]
    ds_read_b64_tr_b16 v[80:81], v160 offset:35840
    ds_read_b64_tr_b16 v[82:83], v160 offset:37888
    v_mfma_f32_32x32x16_bf16 v[144:159], v[84:87], v[208:211], v[144:159]
    ds_read_b64_tr_b16 v[84:85], v8 offset:35840
    ds_read_b64_tr_b16 v[86:87], v8 offset:37888
    v_mfma_f32_32x32x16_bf16 v[128:143], v[88:91], v[212:215], v[128:143]
    ds_read_b64_tr_b16 v[88:89], v160 offset:43008
    ds_read_b64_tr_b16 v[90:91], v160 offset:45056
    v_mfma_f32_32x32x16_bf16 v[144:159], v[92:95], v[212:215], v[144:159]
    ds_read_b64_tr_b16 v[92:93], v8 offset:43008
    ds_read_b64_tr_b16 v[94:95], v8 offset:45056
    v_mfma_f32_32x32x16_bf16 v[128:143], v[96:99], v[216:219], v[128:143]
    ds_read_b64_tr_b16 v[96:97], v160 offset:50176
    ds_read_b64_tr_b16 v[98:99], v160 offset:52224
    v_mfma_f32_32x32x16_bf16 v[144:159], v[100:103], v[216:219], v[144:159]
    ds_read_b64_tr_b16 v[100:101], v8 offset:50176
    ds_read_b64_tr_b16 v[102:103], v8 offset:52224
    v_mfma_f32_32x32x16_bf16 v[128:143], v[104:107], v[220:223], v[128:143]
    ds_read_b64_tr_b16 v[104:105], v161 offset:32768
    ds_read_b64_tr_b16 v[106:107], v161 offset:34816
    v_mfma_f32_32x32x16_bf16 v[144:159], v[108:111], v[220:223], v[144:159]
    ds_read_b64_tr_b16 v[108:109], v9 offset:32768
    ds_read_b64_tr_b16 v[110:111], v9 offset:34816
    v_mfma_f32_32x32x16_bf16 v[128:143], v[112:115], v[224:227], v[128:143]
    ds_read_b64_tr_b16 v[112:113], v161 offset:47104
    ds_read_b64_tr_b16 v[114:115], v161 offset:49152
    v_mfma_f32_32x32x16_bf16 v[144:159], v[116:119], v[224:227], v[144:159]
    ds_read_b64_tr_b16 v[116:117], v9 offset:47104
    ds_read_b64_tr_b16 v[118:119], v9 offset:49152
    v_mfma_f32_32x32x16_bf16 v[128:143], v[120:123], v[228:231], v[128:143]
    ds_read_b64_tr_b16 v[120:121], v162 offset:33792
    ds_read_b64_tr_b16 v[122:123], v162 offset:40960
    v_mfma_f32_32x32x16_bf16 v[144:159], v[124:127], v[228:231], v[144:159]
    ds_read_b64_tr_b16 v[124:125], v10 offset:33792
    ds_read_b64_tr_b16 v[126:127], v10 offset:40960
    s_mov_b32 s63, 4194304
L_any:
    ds_read2_b32 v[248:249], v167 offset0:0 offset1:2
    s_sub_u32 s63, s63, 1
    s_cbranch_scc1 L_end
    s_waitcnt lgkmcnt(0)
    v_cmp_ne_u32 vcc, 0, v249
    s_cbranch_vccnz L_ba
    v_cmp_ne_u32 vcc, 0, v248
    s_cbranch_vccz L_any
    ds_read_b128 v[208:211], v168 offset:28672
    ds_read_b128 v[212:215], v168 offset:30464
    ds_read_b128 v[216:219], v168 offset:32256
    ds_read_b128 v[220:223], v168 offset:34048
    ds_read_b128 v[224:227], v169 offset:29696
    ds_read_b128 v[228:231], v169 offset:33280
    ds_read_b64 v[232:233], v170 offset:30208
    ds_read_b64 v[234:235], v170 offset:32000
    s_waitcnt lgkmcnt(7)
    v_mfma_f32_32x32x16_bf16 v[128:143], v[16:19], v[208:211], v[128:143]
    v_mfma_f32_32x32x16_bf16 v[144:159], v[20:23], v[208:211], v[144:159]
    s_waitcnt lgkmcnt(6)
    v_mfma_f32_32x32x16_bf16 v[128:143], v[24:27], v[212:215], v[128:143]
    v_mfma_f32_32x32x16_bf16 v[144:159], v[28:31], v[212:215], v[144:159]
    s_waitcnt lgkmcnt(5)
    v_mfma_f32_32x32x16_bf16 v[128:143], v[32:35], v[216:219], v[128:143]
    v_mfma_f32_32x32x16_bf16 v[144:159], v[36:39], v[216:219], v[144:159]
    s_waitcnt lgkmcnt(4)
    v_mfma_f32_32x32x16_bf16 v[128:143], v[40:43], v[220:223], v[128:143]
    v_mfma_f32_32x32x16_bf16 v[144:159], v[44:47], v[220:223], v[144:159]
    s_waitcnt lgkmcnt(3)
    v_mfma_f32_32x32x16_bf16 v[128:143], v[48:51], v[224:227], v[128:143]
    v_mfma_f32_32x32x16_bf16 v[144:159], v[52:55], v[224:227], v[144:159]
    s_waitcnt lgkmcnt(2)
    v_mfma_f32_32x32x16_bf16 v[128:143], v[56:59], v[228:231], v[128:143]
    v_mfma_f32_32x32x16_bf16 v[144:159], v[60:63], v[228:231], v[144:159]
    s_waitcnt lgkmcnt(0)
    v_mfma_f32_32x32x16_bf16 v[128:143], v[64:67], v[232:235], v[128:143]
    v_mfma_f32_32x32x16_bf16 v[144:159], v[68:71], v[232:235], v[144:159]
    s_mov_b32 s63, 4194304
L_u0:
    ds_read_b32 v248, v167 offset:8
    s_sub_u32 s63, s63, 1
    s_cbranch_scc1 L_end
    s_waitcnt lgkmcnt(0)
    v_cmp_ne_u32 vcc, 0, v248
    s_cbranch_vccz L_u0
    ds_read_b128 v[208:211], v168 offset:35840
    ds_read_b128 v[212:215], v168 offset:37632
    ds_read_b128 v[216:219], v168 offset:39424
    ds_read_b128 v[220:223], v168 offset:41216
    ds_read_b128 v[224:227], v169 offset:36864
    ds_read_b128 v[228:231], v169 offset:40448
    ds_read_b64 v[232:233], v170 offset:37376
    ds_read_b64 v[234:235], v170 offset:39168
    s_waitcnt lgkmcnt(7)
    v_mfma_f32_32x32x16_bf16 v[176:191], v[72:75], v[208:211], 0
    s_waitcnt lgkmcnt(6)
    v_mfma_f32_32x32x16_bf16 v[176:191], v[80:83], v[212:215], v[176:191]
    s_waitcnt lgkmcnt(5)
    v_mfma_f32_32x32x16_bf16 v[176:191], v[88:91], v[216:219], v[176:191]
    s_waitcnt lgkmcnt(4)
    v_mfma_f32_32x32x16_bf16 v[176:191], v[96:99], v[220:223], v[176:191]
    s_waitcnt lgkmcnt(3)
    v_mfma_f32_32x32x16_bf16 v[176:191], v[104:107], v[224:227], v[176:191]
    s_waitcnt lgkmcnt(2)
    v_mfma_f32_32x32x16_bf16 v[176:191], v[112:115], v[228:231], v[176:191]
    s_waitcnt lgkmcnt(0)
    v_mfma_f32_32x32x16_bf16 v[176:191], v[120:123], v[232:235], v[176:191]
    v_mfma_f32_32x32x16_bf16 v[192:207], v[76:79], v[208:211], 0
    s_nop 4
    v_mfma_f32_32x32x16_bf16 v[192:207], v[84:87], v[212:215], v[192:207]
    s_nop 4
    v_mfma_f32_32x32x16_bf16 v[192:207], v[92:95], v[216:219], v[192:207]
    v_add_f32 v128, v128, v176
    v_add_f32 v129, v129, v177
    v_add_f32 v130, v130, v178
    v_add_f32 v131, v131, v179
    v_cvt_pk_bf16_f32 v128, v128, v129
    v_cvt_pk_bf16_f32 v129, v130, v131
    v_mfma_f32_32x32x16_bf16 v[192:207], v[100:103], v[220:223], v[192:207]
    v_add_f32 v132, v132, v180
    v_add_f32 v133, v133, v181
    v_add_f32 v134, v134, v182
    v_add_f32 v135, v135, v183
    v_cvt_pk_bf16_f32 v130, v132, v133
    v_cvt_pk_bf16_f32 v131, v134, v135
    v_mfma_f32_32x32x16_bf16 v[192:207], v[108:111], v[224:227], v[192:207]
    v_add_f32 v136, v136, v184
    v_add_f32 v137, v137, v185
    v_add_f32 v138, v138, v186
    v_add_f32 v139, v139, v187
    v_cvt_pk_bf16_f32 v132, v136, v137
    v_cvt_pk_bf16_f32 v133, v138, v139
    v_mfma_f32_32x32x16_bf16 v[192:207], v[116:119], v[228:231], v[192:207]
    v_add_f32 v140, v140, v188
    v_add_f32 v141, v141, v189
    v_add_f32 v142, v142, v190
    v_add_f32 v143, v143, v191
    v_cvt_pk_bf16_f32 v134, v140, v141
    v_cvt_pk_bf16_f32 v135, v142, v143
    v_mfma_f32_32x32x16_bf16 v[192:207], v[124:127], v[232:235], v[192:207]
    s_branch L_out
L_ba:
    ds_read_b128 v[208:211], v168 offset:35840
    ds_read_b128 v[212:215], v168 offset:37632
    ds_read_b128 v[216:219], v168 offset:39424
    ds_read_b128 v[220:223], v168 offset:41216
    ds_read_b128 v[224:227], v169 offset:36864
    ds_read_b128 v[228:231], v169 offset:40448
    ds_read_b64 v[232:233], v170 offset:37376
    ds_read_b64 v[234:235], v170 offset:39168
    s_waitcnt lgkmcnt(7)
    v_mfma_f32_32x32x16_bf16 v[176:191], v[72:75], v[208:211], 0
    v_mfma_f32_32x32x16_bf16 v[192:207], v[76:79], v[208:211], 0
    s_waitcnt lgkmcnt(6)
    v_mfma_f32_32x32x16_bf16 v[176:191], v[80:83], v[212:215], v[176:191]
    v_mfma_f32_32x32x16_bf16 v[192:207], v[84:87], v[212:215], v[192:207]
    s_waitcnt lgkmcnt(5)
    v_mfma_f32_32x32x16_bf16 v[176:191], v[88:91], v[216:219], v[176:191]
    v_mfma_f32_32x32x16_bf16 v[192:207], v[92:95], v[216:219], v[192:207]
    s_waitcnt lgkmcnt(4)
    v_mfma_f32_32x32x16_bf16 v[176:191], v[96:99], v[220:223], v[176:191]
    v_mfma_f32_32x32x16_bf16 v[192:207], v[100:103], v[220:223], v[192:207]
    s_waitcnt lgkmcnt(3)
    v_mfma_f32_32x32x16_bf16 v[176:191], v[104:107], v[224:227], v[176:191]
    v_mfma_f32_32x32x16_bf16 v[192:207], v[108:111], v[224:227], v[192:207]
    s_waitcnt lgkmcnt(2)
    v_mfma_f32_32x32x16_bf16 v[176:191], v[112:115], v[228:231], v[176:191]
    v_mfma_f32_32x32x16_bf16 v[192:207], v[116:119], v[228:231], v[192:207]
    s_waitcnt lgkmcnt(0)
    v_mfma_f32_32x32x16_bf16 v[176:191], v[120:123], v[232:235], v[176:191]
    v_mfma_f32_32x32x16_bf16 v[192:207], v[124:127], v[232:235], v[192:207]
    s_mov_b32 s63, 4194304
L_u1:
    ds_read_b32 v248, v167 offset:0
    s_sub_u32 s63, s63, 1
    s_cbranch_scc1 L_end
    s_waitcnt lgkmcnt(0)
    v_cmp_ne_u32 vcc, 0, v248
    s_cbranch_vccz L_u1
    ds_read_b128 v[208:211], v168 offset:28672
    ds_read_b128 v[212:215], v168 offset:30464
    ds_read_b128 v[216:219], v168 offset:32256
    ds_read_b128 v[220:223], v168 offset:34048
    ds_read_b128 v[224:227], v169 offset:29696
    ds_read_b128 v[228:231], v169 offset:33280
    ds_read_b64 v[232:233], v170 offset:30208
    ds_read_b64 v[234:235], v170 offset:32000
    s_waitcnt lgkmcnt(7)
    v_mfma_f32_32x32x16_bf16 v[128:143], v[16:19], v[208:211], v[128:143]
    s_waitcnt lgkmcnt(6)
    v_mfma_f32_32x32x16_bf16 v[128:143], v[24:27], v[212:215], v[128:143]
    s_waitcnt lgkmcnt(5)
    v_mfma_f32_32x32x16_bf16 v[128:143], v[32:35], v[216:219], v[128:143]
    s_waitcnt lgkmcnt(4)
    v_mfma_f32_32x32x16_bf16 v[128:143], v[40:43], v[220:223], v[128:143]
    s_waitcnt lgkmcnt(3)
    v_mfma_f32_32x32x16_bf16 v[128:143], v[48:51], v[224:227], v[128:143]
    s_waitcnt lgkmcnt(2)
    v_mfma_f32_32x32x16_bf16 v[128:143], v[56:59], v[228:231], v[128:143]
    s_waitcnt lgkmcnt(0)
    v_mfma_f32_32x32x16_bf16 v[128:143], v[64:67], v[232:235], v[128:143]
    v_mfma_f32_32x32x16_bf16 v[144:159], v[20:23], v[208:211], v[144:159]
    s_nop 4
    v_mfma_f32_32x32x16_bf16 v[144:159], v[28:31], v[212:215], v[144:159]
    s_nop 4
    v_mfma_f32_32x32x16_bf16 v[144:159], v[36:39], v[216:219], v[144:159]
    v_add_f32 v128, v128, v176
    v_add_f32 v129, v129, v177
    v_add_f32 v130, v130, v178
    v_add_f32 v131, v131, v179
    v_cvt_pk_bf16_f32 v128, v128, v129
    v_cvt_pk_bf16_f32 v129, v130, v131
    v_mfma_f32_32x32x16_bf16 v[144:159], v[44:47], v[220:223], v[144:159]
    v_add_f32 v132, v132, v180
    v_add_f32 v133, v133, v181
    v_add_f32 v134, v134, v182
    v_add_f32 v135, v135, v183
    v_cvt_pk_bf16_f32 v130, v132, v133
    v_cvt_pk_bf16_f32 v131, v134, v135
    v_mfma_f32_32x32x16_bf16 v[144:159], v[52:55], v[224:227], v[144:159]
    v_add_f32 v136, v136, v184
    v_add_f32 v137, v137, v185
    v_add_f32 v138, v138, v186
    v_add_f32 v139, v139, v187
    v_cvt_pk_bf16_f32 v132, v136, v137
    v_cvt_pk_bf16_f32 v133, v138, v139
    v_mfma_f32_32x32x16_bf16 v[144:159], v[60:63], v[228:231], v[144:159]
    v_add_f32 v140, v140, v188
    v_add_f32 v141, v141, v189
    v_add_f32 v142, v142, v190
    v_add_f32 v143, v143, v191
    v_cvt_pk_bf16_f32 v134, v140, v141
    v_cvt_pk_bf16_f32 v135, v142, v143
    v_mfma_f32_32x32x16_bf16 v[144:159], v[68:71], v[232:235], v[144:159]
L_out:
    ds_write_b128 v166, v[128:131]
    ds_write_b128 v11, v[132:135]
    s_nop 9
    v_add_f32 v144, v144, v192
    v_add_f32 v145, v145, v193
    v_add_f32 v146, v146, v194
    v_add_f32 v147, v147, v195
    v_add_f32 v148, v148, v196
    v_add_f32 v149, v149, v197
    v_add_f32 v150, v150, v198
    v_add_f32 v151, v151, v199
    v_cvt_pk_bf16_f32 v144, v144, v145
    v_cvt_pk_bf16_f32 v145, v146, v147
    v_cvt_pk_bf16_f32 v146, v148, v149
    v_cvt_pk_bf16_f32 v147, v150, v151
    ds_write_b128 v12, v[144:147]
    v_add_f32 v152, v152, v200
    v_add_f32 v153, v153, v201
    v_add_f32 v154, v154, v202
    v_add_f32 v155, v155, v203
    v_add_f32 v156, v156, v204
    v_add_f32 v157, v157, v205
    v_add_f32 v158, v158, v206
    v_add_f32 v159, v159, v207
    v_cvt_pk_bf16_f32 v148, v152, v153
    v_cvt_pk_bf16_f32 v149, v154, v155
    v_cvt_pk_bf16_f32 v150, v156, v157
    v_cvt_pk_bf16_f32 v151, v158, v159
    ds_write_b128 v13, v[148:151]
    ds_read_b128 v[16:19], v175 offset:0
    ds_read_b128 v[20:23], v175 offset:1024
    ds_read_b128 v[24:27], v175 offset:2048
    ds_read_b128 v[28:31], v175 offset:3072
    s_waitcnt lgkmcnt(3)
    buffer_store_dwordx4 v[16:19], v174, s[64:67], s8 offen sc1
    s_waitcnt lgkmcnt(2)
    buffer_store_dwordx4 v[20:23], v174, s[64:67], s58 offen sc1
    s_waitcnt lgkmcnt(1)
    buffer_store_dwordx4 v[24:27], v174, s[64:67], s59 offen sc1
    s_waitcnt lgkmcnt(0)
    buffer_store_dwordx4 v[28:31], v174, s[64:67], s25 offen sc1
L_fin:
L_end:
    s_endpgm
L_wfirst:
    s_lshl_b32 s58, s56, 2
    s_lshr_b32 s58, 0x84c0, s58
    s_and_b32 s27, s58, 15
    s_xor_b32 s58, s11, 0
    s_add_u32 s58, s58, s27
    s_mul_i32 s17, s58, 25088
    s_mul_i32 s18, s56, 14336
    s_mov_b32 s59, 0
    s_setprio 0
L_wo0:
    s_mov_b32 m0, s18
    s_add_u32 s59, s59, 1
    buffer_load_dwordx4 v172, s[36:39], s17 offen  lds
    s_add_u32 s18, s18, 1024
    s_cmp_eq_u32 s59, 7
    s_mov_b32 s58, 3584
    s_cselect_b32 s58, 28672, s58
    s_add_u32 s17, s17, s58
    s_cmp_lg_u32 s59, 14
    s_waitcnt vmcnt(5)
    s_cbranch_scc1 L_wo0
    s_waitcnt vmcnt(0)
    s_setprio 2
    s_branch L_pub
L_wt000:
    buffer_store_dwordx4 v[32:35], v15, s[32:35], s45 offen offset:0 sc1
    s_branch L_st000
L_wt001:
    buffer_store_dwordx4 v[36:39], v15, s[32:35], s45 offen offset:1024 sc1
    s_branch L_st001
L_wt010:
    buffer_store_dwordx4 v[48:51], v15, s[32:35], s24 offen offset:0 sc1
    s_branch L_st010
L_wt011:
    buffer_store_dwordx4 v[52:55], v15, s[32:35], s24 offen offset:1024 sc1
    s_branch L_st011
L_wt100:
    buffer_store_dwordx4 v[32:35], v15, s[32:35], s45 offen offset:0 sc1
    s_branch L_st100
L_wt101:
    buffer_store_dwordx4 v[36:39], v15, s[32:35], s45 offen offset:1024 sc1
    s_branch L_st101
L_wt110:
    buffer_store_dwordx4 v[48:51], v15, s[32:35], s24 offen offset:0 sc1
    s_branch L_st110
L_wt111:
    buffer_store_dwordx4 v[52:55], v15, s[32:35], s24 offen offset:1024 sc1
    s_branch L_st111
L_wtc20:
    buffer_store_dwordx4 v[64:67], v15, s[32:35], s25 offen offset:0 sc1
    s_branch L_stc20
L_wtc21:
    buffer_store_dwordx4 v[68:71], v15, s[32:35], s25 offen offset:1024 sc1
    s_branch L_stc21
L_wtc30:
    buffer_store_dwordx4 v[80:83], v15, s[32:35], s26 offen offset:0 sc1
    s_branch L_stc30
L_wtc31:
    buffer_store_dwordx4 v[84:87], v15, s[32:35], s26 offen offset:1024 sc1
    s_branch L_stc31
L_f1wt:
    buffer_store_dwordx2 v[232:233], off, s[32:35], s10 sc1
    s_branch L_f1st
L_nonce_retryL:
    buffer_load_dwordx2 v[232:233], off, s[68:71], s60 sc1
    s_sub_u32 s63, s63, 1
    s_cbranch_scc1 L_end
    s_waitcnt vmcnt(0)
    s_branch L_nonceL
L_nonce_retryC:
    buffer_load_dwordx2 v[232:233], off, s[68:71], s60 sc1
    s_sub_u32 s63, s63, 1
    s_cbranch_scc1 L_end
    s_waitcnt vmcnt(0)
    s_branch L_nonceC
L_fallback:
    s_waitcnt vmcnt(0)
    s_mov_b32 s23, 1
    s_mov_b32 exec_lo, 0
    v_mov_b32 v46, 0
    s_mov_b32 exec_lo, -1
    v_mov_b32 v96, 0
    v_mov_b32 v97, 0
    v_mov_b32 v98, 0
    v_mov_b32 v99, 0
    v_mov_b32 v100, 0
    v_mov_b32 v101, 0
    v_mov_b32 v102, 0
    v_mov_b32 v103, 0
    v_mov_b32 v104, 0
    v_mov_b32 v105, 0
    v_mov_b32 v106, 0
    v_mov_b32 v107, 0
    v_mov_b32 v108, 0
    v_mov_b32 v109, 0
    v_mov_b32 v110, 0
    v_mov_b32 v111, 0
    v_mov_b32 v242, 0xff7fffff
    s_mov_b32 s16, 0
L_fb_loop:
    buffer_load_dwordx4 v[176:179], v1, s[72:75], s16 offen sc1
    buffer_load_dwordx4 v[180:183], v1, s[72:75], s16 offen offset:1024 sc1
    buffer_load_dwordx4 v[208:211], v1, s[72:75], s16 offen offset:2048 sc1
    buffer_load_dwordx4 v[212:215], v1, s[72:75], s16 offen offset:3072 sc1
    s_waitcnt vmcnt(0)
    v_mfma_f32_32x32x16_bf16 v[112:127], v[176:179], v[40:43], 0
    v_mfma_f32_32x32x16_bf16 v[112:127], v[180:183], v[44:47], v[112:127]
    s_nop 15
    v_max3_f32 v240, v242, v112, v113
    v_max3_f32 v240, v240, v114, v115
    v_max3_f32 v240, v240, v116, v117
    v_max3_f32 v240, v240, v118, v119
    v_max3_f32 v240, v240, v120, v121
    v_max3_f32 v240, v240, v122, v123
    v_max3_f32 v240, v240, v124, v125
    v_max3_f32 v240, v240, v126, v127
    v_mov_b32 v241, v240
    s_nop 1
    v_permlane32_swap_b32 v240, v241
    v_max_f32 v240, v240, v241
    v_sub_f32 v241, v242, v240
    v_exp_f32 v241, v241
    v_mov_b32 v242, v240
    v_sub_f32 v112, v112, v240
    v_sub_f32 v113, v113, v240
    v_sub_f32 v114, v114, v240
    v_sub_f32 v115, v115, v240
    v_sub_f32 v116, v116, v240
    v_sub_f32 v117, v117, v240
    v_sub_f32 v118, v118, v240
    v_sub_f32 v119, v119, v240
    v_sub_f32 v120, v120, v240
    v_sub_f32 v121, v121, v240
    v_sub_f32 v122, v122, v240
    v_sub_f32 v123, v123, v240
    v_sub_f32 v124, v124, v240
    v_sub_f32 v125, v125, v240
    v_sub_f32 v126, v126, v240
    v_sub_f32 v127, v127, v240
    v_exp_f32 v112, v112
    v_exp_f32 v113, v113
    v_exp_f32 v114, v114
    v_exp_f32 v115, v115
    v_exp_f32 v116, v116
    v_exp_f32 v117, v117
    v_exp_f32 v118, v118
    v_exp_f32 v119, v119
    v_exp_f32 v120, v120
    v_exp_f32 v121, v121
    v_exp_f32 v122, v122
    v_exp_f32 v123, v123
    v_exp_f32 v124, v124
    v_exp_f32 v125, v125
    v_exp_f32 v126, v126
    v_exp_f32 v127, v127
    v_mul_f32 v96, v96, v241
    v_mul_f32 v97, v97, v241
    v_mul_f32 v98, v98, v241
    v_mul_f32 v99, v99, v241
    v_mul_f32 v100, v100, v241
    v_mul_f32 v101, v101, v241
    v_mul_f32 v102, v102, v241
    v_mul_f32 v103, v103, v241
    v_mul_f32 v104, v104, v241
    v_mul_f32 v105, v105, v241
    v_mul_f32 v106, v106, v241
    v_mul_f32 v107, v107, v241
    v_mul_f32 v108, v108, v241
    v_mul_f32 v109, v109, v241
    v_mul_f32 v110, v110, v241
    v_mul_f32 v111, v111, v241
    s_nop 1
    v_smfmac_f32_32x32x32_bf16 v[96:111], v[208:211], v[112:119], v2
    v_smfmac_f32_32x32x32_bf16 v[96:111], v[212:215], v[120:127], v2
    s_add_u32 s16, s16, 4096
    s_cmp_lt_u32 s16, 262144
    s_nop 15
    s_cbranch_scc1 L_fb_loop
    v_mov_b32 v240, v108
    v_mov_b32 v241, v108
    s_nop 1
    v_permlane32_swap_b32 v240, v241
    s_branch L_norm
.section .rodata,"a"
.p2align 6
.amdhsa_kernel concat_heads__softmax_full_mha__softmax_full_mha__prompt_kernel
  .amdhsa_next_free_vgpr 256
  .amdhsa_next_free_sgpr 102
  .amdhsa_accum_offset 256
  .amdhsa_group_segment_fixed_size 0
  .amdhsa_kernarg_size 72
  .amdhsa_user_sgpr_count 2
  .amdhsa_user_sgpr_kernarg_segment_ptr 1
  .amdhsa_system_sgpr_workgroup_id_x 1
.end_amdhsa_kernel
```
